```python
import torch

def _softmax(x, axis=-1):
    return torch.softmax(x, dim=axis)
def _gelu(x):
    return torch.nn.functional.gelu(x, approximate="tanh")
def _silu(x):
    return torch.nn.functional.silu(x)
def _sigmoid(x):
    return torch.sigmoid(x)
def _layernorm(x, axis=-1, eps=1e-5):
    m = x.mean(dim=axis, keepdim=True)
    v = x.var(dim=axis, keepdim=True, unbiased=False)
    return (x - m) / torch.sqrt(v + eps)
def _scatter_add(tgt, idx, src, axis=0):
    return tgt.clone().index_add_(axis, idx, src)
def _segment_sum(src, seg, n):
    out = torch.zeros((n,) + src.shape[1:], dtype=src.dtype)
    return out.index_add_(0, seg, src)
def _pad(x, pw):
    flat = tuple(v for pair in reversed(pw) for v in pair)
    return torch.nn.functional.pad(x, flat)

kernel_name = 'concat_heads__mha_block_cached__mha_block_cached__near_ridge'

def setup_inputs():

    _w = (lambda a: (lambda t: t.to(torch.bfloat16) if t.is_floating_point() else t)(torch.as_tensor(a)))
    def _A_setup():
        B, Sq, D = 16, 64, 1024
        H, Sk, Dh = 32, 512, 128
        return {
            "x": _w((lambda *s: torch.randn(*s, dtype=torch.bfloat16) * 0.8)(B, Sq, D)),
            "k_cache": _w((lambda *s: torch.randn(*s, dtype=torch.bfloat16) * 0.8)(B, H, Sk, Dh)),
            "v_cache": _w((lambda *s: torch.randn(*s, dtype=torch.bfloat16) * 0.05)(B, H, Sk, Dh)),
            "wq": _w((lambda *s: torch.randn(*s, dtype=torch.bfloat16) * 0.8)(D, H * Dh) * (D ** -0.5)),
            "wo": _w((lambda *s: torch.randn(*s, dtype=torch.bfloat16) * 0.05)(H * Dh, D) * ((H * Dh) ** -0.5)),
        }
    _A_in = _A_setup()

    def _B_setup():
        B, Sq, D = 16, 64, 1024
        H, Sk, Dh = 32, 512, 128
        return {
            "x": _w((lambda *s: torch.randn(*s, dtype=torch.bfloat16) * 0.8)(B, Sq, D)),
            "k_cache": _w((lambda *s: torch.randn(*s, dtype=torch.bfloat16) * 0.8)(B, H, Sk, Dh)),
            "v_cache": _w((lambda *s: torch.randn(*s, dtype=torch.bfloat16) * 0.05)(B, H, Sk, Dh)),
            "wq": _w((lambda *s: torch.randn(*s, dtype=torch.bfloat16) * 0.8)(D, H * Dh) * (D ** -0.5)),
            "wo": _w((lambda *s: torch.randn(*s, dtype=torch.bfloat16) * 0.05)(H * Dh, D) * ((H * Dh) ** -0.5)),
        }
    _B_in = _B_setup()

    return {
        "A_x": _A_in["x"],
        "A_k_cache": _A_in["k_cache"],
        "A_v_cache": _A_in["v_cache"],
        "A_wq": _A_in["wq"],
        "A_wo": _A_in["wo"],
        "B_x": _B_in["x"],
        "B_k_cache": _B_in["k_cache"],
        "B_v_cache": _B_in["v_cache"],
        "B_wq": _B_in["wq"],
        "B_wo": _B_in["wo"],
    }

def reference(A_x, A_k_cache, A_v_cache, A_wq, A_wo, B_x, B_k_cache, B_v_cache, B_wq, B_wo):
    def _A_ref(x, k_cache, v_cache, wq, wo):
        B, Sq, D = x.shape
        H, Dh = 32, 128
        q = (lambda x, *d: x.permute(*d))((x @ wq).reshape(B, Sq, H, Dh), 0, 2, 1, 3)
        scores = torch.einsum("bhqd,bhkd->bhqk", q, k_cache) * (Dh ** -0.5)
        p = _softmax(scores, axis=-1)
        o = torch.einsum("bhqk,bhkd->bhqd", p, v_cache)
        return (lambda x, *d: x.permute(*d))(o, 0, 2, 1, 3).reshape(B, Sq, H * Dh) @ wo

    def _B_ref(x, k_cache, v_cache, wq, wo):
        B, Sq, D = x.shape
        H, Dh = 32, 128
        q = (lambda x, *d: x.permute(*d))((x @ wq).reshape(B, Sq, H, Dh), 0, 2, 1, 3)
        scores = torch.einsum("bhqd,bhkd->bhqk", q, k_cache) * (Dh ** -0.5)
        p = _softmax(scores, axis=-1)
        o = torch.einsum("bhqk,bhkd->bhqd", p, v_cache)
        return (lambda x, *d: x.permute(*d))(o, 0, 2, 1, 3).reshape(B, Sq, H * Dh) @ wo

    a = _A_ref(A_x, A_k_cache, A_v_cache, A_wq, A_wo)
    b = _B_ref(B_x, B_k_cache, B_v_cache, B_wq, B_wo)
    return torch.concatenate([a, b], axis=-1)
```

```asm
; @launch grid=(256,1,1) block=(256,1,1) lds=163840
.amdgcn_target "amdgcn-amd-amdhsa--gfx950"
.text
.globl concat_heads__mha_block_cached__mha_block_cached__near_ridge_kernel
.p2align 8
.type concat_heads__mha_block_cached__mha_block_cached__near_ridge_kernel,@function
concat_heads__mha_block_cached__mha_block_cached__near_ridge_kernel:
    s_cmp_ge_u32 s2, 256
    s_cbranch_scc1 L1_end
    s_load_dwordx8 s[4:11], s[0:1], 0
    s_load_dwordx8 s[12:19], s[0:1], 40
    s_load_dwordx2 s[20:21], s[0:1], 96
    s_load_dwordx2 s[86:87], s[0:1], 88
    v_lshrrev_b32 v24, 6, v0
    v_and_b32 v1, 63, v0
    v_readfirstlane_b32 s22, v24
    s_and_b32 s58, s2, 7
    s_lshr_b32 s59, s2, 3
    s_lshr_b32 s23, s58, 2
    s_and_b32 s58, s58, 3
    s_and_b32 s47, s59, 7
    s_lshl_b32 s58, s58, 3
    s_add_u32 s44, s58, s47
    s_lshr_b32 s45, s59, 3
    s_lshl_b32 s46, s45, 2
    s_add_u32 s46, s46, s22
    s_lshl_b32 s48, s22, 15
    s_lshl_b32 s49, s22, 11
    s_add_u32 s49, s49, 131072
    v_lshrrev_b32 v24, 3, v1
    v_lshrrev_b32 v25, 4, v1
    v_and_b32 v26, 7, v1
    v_xor_b32 v26, v26, v25
    v_lshlrev_b32 v27, 11, v24
    v_lshl_add_u32 v28, v26, 4, v27
    v_xor_b32 v29, 64, v28
    v_add_u32 v2, 0, v28
    v_add_u32 v3, 15360, v29
    v_add_u32 v4, 30720, v28
    v_add_u32 v5, 46080, v29
    v_add_u32 v6, 65536, v28
    v_add_u32 v7, 80896, v29
    v_add_u32 v8, 96256, v28
    v_add_u32 v9, 111616, v29
    v_and_b32 v26, 15, v1
    v_lshlrev_b32 v27, 2, v25
    v_xor_b32 v27, v27, v26
    v_lshlrev_b32 v27, 4, v27
    v_lshl_add_u32 v36, v25, 8, v27
    v_lshlrev_b32 v27, 1, v25
    v_xor_b32 v27, v27, v26
    s_and_b32 s58, s22, 1
    s_lshl_b32 s58, s58, 3
    v_xor_b32 v27, s58, v27
    v_lshlrev_b32 v27, 4, v27
    v_lshl_add_u32 v28, v25, 13, v27
    s_lshl_b32 s58, s22, 16
    v_add_u32 v10, s58, v28
    v_add_u32 v11, 31744, v10
    s_waitcnt lgkmcnt(0)
    s_cmp_eq_u32 s23, 0
    s_cselect_b32 s4, s4, s12
    s_cselect_b32 s5, s5, s13
    s_cselect_b32 s6, s6, s14
    s_cselect_b32 s7, s7, s15
    s_cselect_b32 s8, s8, s16
    s_cselect_b32 s9, s9, s17
    s_cselect_b32 s10, s10, s18
    s_cselect_b32 s11, s11, s19
    s_lshl_b32 s58, s46, 17
    s_add_u32 s24, s4, s58
    s_addc_u32 s25, s5, 0
    s_mov_b32 s26, 131072
    s_mov_b32 s27, 0x00020000
    s_lshl_b32 s58, s44, 8
    s_add_u32 s28, s10, s58
    s_addc_u32 s29, s11, 0
    s_sub_u32 s30, 8388608, s58
    s_mov_b32 s31, 0x00020000
    s_add_u32 s58, s45, s47
    s_and_b32 s58, s58, 3
    s_mov_b32 s82, 0x75463102
    s_mov_b32 s83, 0xfdceb98a
    s_cmp_eq_u32 s58, 1
    s_cselect_b32 s82, 0x65742130, s82
    s_cselect_b32 s83, 0xedfca9b8, s83
    s_cmp_eq_u32 s58, 2
    s_cselect_b32 s82, 0x68532410, s82
    s_cselect_b32 s83, 0xfedbac97, s83
    s_cmp_eq_u32 s58, 3
    s_cselect_b32 s82, 0x96435210, s82
    s_cselect_b32 s83, 0xfecbda87, s83
    s_mov_b64 s[84:85], s[82:83]
    s_and_b32 s50, s82, 15
    s_lshl_b32 s51, s50, 19
    s_lshl_b32 s50, s50, 7
    s_mul_i32 s63, s46, 5
    s_add_u32 s63, s63, s44
    s_and_b32 s63, s63, 15
    s_add_u32 s64, s20, 41943040
    s_addc_u32 s65, s21, 0
    s_mov_b32 s66, 262144
    s_mov_b32 s67, 0x00020000
    s_lshl_b32 s68, s2, 2
    s_add_u32 s68, s68, s22
    s_lshl_b32 s68, s68, 7
    v_lshlrev_b32 v14, 17, v1
    v_mov_b32 v15, 0
    s_mov_b64 exec, 3
    buffer_store_dword v15, v14, s[64:67], s68 offen sc1
    s_mov_b64 exec, -1
    s_add_u32 m0, s48, 16384
    s_nop 0
    buffer_load_dwordx4 v2, s[24:27], s50 offen offset:0 lds
    buffer_load_dwordx4 v3, s[24:27], s50 offen offset:1024 lds
    s_add_u32 m0, s49, 0
    s_nop 0
    buffer_load_dwordx4 v10, s[28:31], s51 offen offset:0 lds
    s_add_u32 m0, s48, 16384
    s_nop 0
    buffer_load_dwordx4 v4, s[24:27], s50 offen offset:2048 lds
    buffer_load_dwordx4 v5, s[24:27], s50 offen offset:3072 lds
    s_add_u32 m0, s49, 0
    s_nop 0
    buffer_load_dwordx4 v11, s[28:31], s51 offen offset:1024 lds
    s_add_u32 s51, s51, 262144
    s_add_u32 m0, s48, 20480
    s_nop 0
    buffer_load_dwordx4 v6, s[24:27], s50 offen offset:0 lds
    buffer_load_dwordx4 v7, s[24:27], s50 offen offset:1024 lds
    buffer_load_dwordx4 v8, s[24:27], s50 offen offset:2048 lds
    buffer_load_dwordx4 v9, s[24:27], s50 offen offset:3072 lds
    s_lshr_b64 s[82:83], s[82:83], 4
    s_and_b32 s50, s82, 15
    s_lshl_b32 s50, s50, 7
    v_lshrrev_b32 v24, 3, v1
    v_lshrrev_b32 v25, 4, v1
    v_lshlrev_b32 v27, 11, v24
    v_and_b32 v26, 7, v1
    v_lshl_add_u32 v26, v26, 6, v27
    s_lshl_b32 s58, s47, 14
    s_add_u32 s58, s58, 256
    v_add_u32 v12, s58, v26
    v_and_b32 v26, 15, v1
    v_and_b32 v27, 3, v1
    v_lshlrev_b32 v27, 6, v27
    v_bfe_u32 v28, v1, 2, 2
    v_lshl_add_u32 v27, v28, 13, v27
    v_lshl_add_u32 v27, v25, 19, v27
    s_lshl_b32 s58, s45, 2
    s_add_u32 s58, s58, s22
    s_lshl_b32 s58, s58, 15
    s_add_u32 s58, s58, 1048576
    v_add_u32 v13, s58, v27
    v_xor_b32 v27, v26, v25
    v_lshlrev_b32 v27, 4, v27
    v_lshl_add_u32 v32, v25, 8, v27
    v_xor_b32 v33, 64, v32
    v_xor_b32 v34, 128, v32
    v_xor_b32 v35, 192, v32
    v_and_b32 v24, 31, v1
    v_lshrrev_b32 v25, 5, v1
    v_bfe_u32 v26, v1, 1, 3
    v_xor_b32 v26, v26, v25
    v_lshlrev_b32 v26, 4, v26
    v_lshl_add_u32 v26, v24, 7, v26
    v_add_u32 v16, s48, v26
    v_xor_b32 v17, 32, v16
    v_xor_b32 v18, 64, v16
    v_xor_b32 v19, 96, v16
    v_and_b32 v26, 15, v1
    v_xor_b32 v26, v26, v25
    v_lshlrev_b32 v26, 4, v26
    v_lshl_add_u32 v26, v24, 8, v26
    v_add_u32 v38, s48, v26
    v_xor_b32 v39, 32, v38
    v_xor_b32 v40, 64, v38
    v_xor_b32 v41, 96, v38
    v_xor_b32 v42, 128, v38
    v_xor_b32 v43, 160, v38
    v_xor_b32 v44, 192, v38
    v_xor_b32 v45, 224, v38
    v_bfe_u32 v24, v1, 2, 2
    v_and_b32 v26, 3, v1
    v_bfe_u32 v27, v1, 4, 1
    v_lshl_add_u32 v28, v25, 2, v24
    v_lshlrev_b32 v28, 8, v28
    v_lshl_add_u32 v28, v24, 6, v28
    v_lshl_add_u32 v28, v27, 5, v28
    v_lshl_add_u32 v29, v26, 3, v28
    v_add_u32 v46, s48, v29
    v_xor_b32 v47, 64, v46
    v_xor_b32 v48, 128, v46
    v_xor_b32 v49, 192, v46
    v_lshl_add_u32 v28, v25, 3, v24
    v_lshlrev_b32 v28, 8, v28
    v_lshl_add_u32 v28, v24, 6, v28
    v_lshl_add_u32 v28, v27, 5, v28
    v_and_b32 v27, 1, v26
    v_lshrrev_b32 v26, 1, v26
    v_lshl_add_u32 v28, v27, 4, v28
    v_lshl_add_u32 v28, v26, 3, v28
    v_add_u32 v20, 131072, v28
    v_xor_b32 v21, 64, v20
    v_xor_b32 v22, 128, v20
    v_xor_b32 v23, 192, v20
    v_lshlrev_b32 v37, 4, v1
    v_and_b32 v24, 15, v1
    v_lshrrev_b32 v25, 4, v1
    v_bfe_u32 v26, v1, 1, 3
    v_xor_b32 v26, v26, v25
    v_lshlrev_b32 v26, 4, v26
    v_lshl_add_u32 v26, v24, 7, v26
    v_add_u32 v16, s48, v26
    v_xor_b32 v17, 64, v16
    v_bfe_u32 v24, v1, 2, 2
    v_lshl_add_u32 v26, v25, 3, v24
    v_lshlrev_b32 v26, 8, v26
    v_and_b32 v25, 1, v25
    v_lshl_add_u32 v24, v25, 2, v24
    v_lshl_add_u32 v26, v24, 5, v26
    v_and_b32 v24, 3, v1
    v_lshl_add_u32 v26, v24, 3, v26
    v_add_u32 v52, 131072, v26
    v_xor_b32 v53, 32, v52
    v_xor_b32 v54, 64, v52
    v_xor_b32 v55, 96, v52
    v_xor_b32 v56, 128, v52
    v_xor_b32 v57, 160, v52
    v_xor_b32 v58, 192, v52
    v_xor_b32 v59, 224, v52
    s_mov_b32 s57, 0x3e0293ee
    s_mov_b32 s69, 0x427af233
    s_lshl_b32 s58, s46, 5
    s_add_u32 s58, s58, s44
    s_lshl_b32 s58, s58, 17
    s_add_u32 s32, s6, s58
    s_addc_u32 s33, s7, 0
    s_mov_b32 s34, 131072
    s_mov_b32 s35, 0x00020000
    s_add_u32 s36, s8, s58
    s_addc_u32 s37, s9, 0
    s_mov_b32 s38, 131072
    s_mov_b32 s39, 0x00020000
    s_lshl_b32 s58, s23, 23
    s_add_u32 s40, s20, s58
    s_addc_u32 s41, s21, 0
    s_mov_b32 s42, 8388608
    s_mov_b32 s43, 0x00020000
    s_add_u32 m0, s49, 8192
    s_nop 0
    buffer_load_dwordx4 v10, s[28:31], s51 offen offset:0 lds
    buffer_load_dwordx4 v11, s[28:31], s51 offen offset:1024 lds
    s_lshr_b64 s[84:85], s[84:85], 4
    s_and_b32 s51, s84, 15
    s_lshl_b32 s51, s51, 19
    s_add_u32 m0, s48, 24576
    s_nop 0
    buffer_load_dwordx4 v2, s[24:27], s50 offen offset:0 lds
    buffer_load_dwordx4 v3, s[24:27], s50 offen offset:1024 lds
    s_add_u32 m0, s49, 16384
    s_nop 0
    buffer_load_dwordx4 v10, s[28:31], s51 offen offset:0 lds
    s_add_u32 m0, s48, 24576
    s_nop 0
    buffer_load_dwordx4 v4, s[24:27], s50 offen offset:2048 lds
    buffer_load_dwordx4 v5, s[24:27], s50 offen offset:3072 lds
    s_add_u32 m0, s49, 16384
    s_nop 0
    buffer_load_dwordx4 v11, s[28:31], s51 offen offset:1024 lds
    s_add_u32 s51, s51, 262144
    s_add_u32 m0, s48, 28672
    s_nop 0
    buffer_load_dwordx4 v6, s[24:27], s50 offen offset:0 lds
    buffer_load_dwordx4 v7, s[24:27], s50 offen offset:1024 lds
    buffer_load_dwordx4 v8, s[24:27], s50 offen offset:2048 lds
    buffer_load_dwordx4 v9, s[24:27], s50 offen offset:3072 lds
    s_lshr_b64 s[82:83], s[82:83], 4
    s_and_b32 s50, s82, 15
    s_lshl_b32 s50, s50, 7
    s_add_u32 m0, s49, 24576
    s_nop 0
    buffer_load_dwordx4 v10, s[28:31], s51 offen offset:0 lds
    buffer_load_dwordx4 v11, s[28:31], s51 offen offset:1024 lds
    s_lshr_b64 s[84:85], s[84:85], 4
    s_and_b32 s51, s84, 15
    s_lshl_b32 s51, s51, 19
    s_waitcnt vmcnt(14)
    s_barrier
    s_cmp_eq_u32 s22, 0
    s_cbranch_scc0 L1_noc
    s_mov_b32 s64, s86
    s_mov_b32 s65, s87
    s_mov_b32 s66, 256
    s_mov_b32 s67, 0x00020000
    s_and_b32 s68, s2, 1
    s_lshl_b32 s68, s68, 7
    v_mov_b32 v14, 1
    v_mov_b32 v15, 0
    s_mov_b64 exec, 1
    buffer_atomic_add v14, v15, s[64:67], s68 offen
    s_mov_b64 exec, -1
L1_noc:
    ds_read_b64_tr_b16 a[0:1], v52 offset:0
    ds_read_b64_tr_b16 a[2:3], v52 offset:1024
    ds_read_b64_tr_b16 a[4:5], v53 offset:0
    ds_read_b64_tr_b16 a[6:7], v53 offset:1024
    ds_read_b64_tr_b16 a[8:9], v54 offset:0
    ds_read_b64_tr_b16 a[10:11], v54 offset:1024
    ds_read_b64_tr_b16 a[12:13], v55 offset:0
    ds_read_b64_tr_b16 a[14:15], v55 offset:1024
    ds_read_b64_tr_b16 a[16:17], v56 offset:0
    ds_read_b64_tr_b16 a[18:19], v56 offset:1024
    ds_read_b64_tr_b16 a[20:21], v57 offset:0
    ds_read_b64_tr_b16 a[22:23], v57 offset:1024
    ds_read_b64_tr_b16 a[24:25], v58 offset:0
    ds_read_b64_tr_b16 a[26:27], v58 offset:1024
    ds_read_b64_tr_b16 a[28:29], v59 offset:0
    ds_read_b64_tr_b16 a[30:31], v59 offset:1024
    ds_read_b128 a[64:67], v16 offset:16384
    ds_read_b128 a[68:71], v16 offset:18432
    ds_read_b128 a[72:75], v16 offset:20480
    ds_read_b128 a[76:79], v16 offset:22528
    ds_read_b128 a[80:83], v17 offset:16384
    ds_read_b128 a[84:87], v17 offset:18432
    ds_read_b128 a[88:91], v17 offset:20480
    ds_read_b128 a[92:95], v17 offset:22528
    s_waitcnt vmcnt(12) lgkmcnt(0)
    s_barrier
    v_mfma_f32_16x16x32_bf16 v[128:131], a[0:3], a[64:67], 0
    s_add_u32 m0, s48, 16384
    ds_read_b64_tr_b16 a[32:33], v52 offset:8192
    buffer_load_dwordx4 v2, s[24:27], s50 offen offset:0 lds
    v_mfma_f32_16x16x32_bf16 v[132:135], a[0:3], a[68:71], 0
    ds_read_b64_tr_b16 a[34:35], v52 offset:9216
    v_mfma_f32_16x16x32_bf16 v[136:139], a[0:3], a[72:75], 0
    ds_read_b64_tr_b16 a[36:37], v53 offset:8192
    v_mfma_f32_16x16x32_bf16 v[140:143], a[0:3], a[76:79], 0
    buffer_load_dwordx4 v3, s[24:27], s50 offen offset:1024 lds
    v_mfma_f32_16x16x32_bf16 v[144:147], a[4:7], a[64:67], 0
    ds_read_b64_tr_b16 a[38:39], v53 offset:9216
    v_mfma_f32_16x16x32_bf16 v[148:151], a[4:7], a[68:71], 0
    ds_read_b64_tr_b16 a[40:41], v54 offset:8192
    v_mfma_f32_16x16x32_bf16 v[152:155], a[4:7], a[72:75], 0
    s_add_u32 m0, s49, 0
    ds_read_b64_tr_b16 a[42:43], v54 offset:9216
    buffer_load_dwordx4 v10, s[28:31], s51 offen offset:0 lds
    v_mfma_f32_16x16x32_bf16 v[156:159], a[4:7], a[76:79], 0
    v_mfma_f32_16x16x32_bf16 v[160:163], a[8:11], a[64:67], 0
    ds_read_b64_tr_b16 a[44:45], v55 offset:8192
    v_mfma_f32_16x16x32_bf16 v[164:167], a[8:11], a[68:71], 0
    s_add_u32 m0, s48, 16384
    ds_read_b64_tr_b16 a[46:47], v55 offset:9216
    buffer_load_dwordx4 v4, s[24:27], s50 offen offset:2048 lds
    v_mfma_f32_16x16x32_bf16 v[168:171], a[8:11], a[72:75], 0
    v_mfma_f32_16x16x32_bf16 v[172:175], a[8:11], a[76:79], 0
    ds_read_b64_tr_b16 a[48:49], v56 offset:8192
    v_mfma_f32_16x16x32_bf16 v[176:179], a[12:15], a[64:67], 0
    ds_read_b64_tr_b16 a[50:51], v56 offset:9216
    buffer_load_dwordx4 v5, s[24:27], s50 offen offset:3072 lds
    v_mfma_f32_16x16x32_bf16 v[180:183], a[12:15], a[68:71], 0
    ds_read_b64_tr_b16 a[52:53], v57 offset:8192
    v_mfma_f32_16x16x32_bf16 v[184:187], a[12:15], a[72:75], 0
    v_mfma_f32_16x16x32_bf16 v[188:191], a[12:15], a[76:79], 0
    s_add_u32 m0, s49, 0
    ds_read_b64_tr_b16 a[54:55], v57 offset:9216
    buffer_load_dwordx4 v11, s[28:31], s51 offen offset:1024 lds
    s_add_u32 s51, s51, 262144
    v_mfma_f32_16x16x32_bf16 v[192:195], a[16:19], a[64:67], 0
    ds_read_b64_tr_b16 a[56:57], v58 offset:8192
    v_mfma_f32_16x16x32_bf16 v[196:199], a[16:19], a[68:71], 0
    ds_read_b64_tr_b16 a[58:59], v58 offset:9216
    s_add_u32 m0, s48, 20480
    v_mfma_f32_16x16x32_bf16 v[200:203], a[16:19], a[72:75], 0
    buffer_load_dwordx4 v6, s[24:27], s50 offen offset:0 lds
    v_mfma_f32_16x16x32_bf16 v[204:207], a[16:19], a[76:79], 0
    ds_read_b64_tr_b16 a[60:61], v59 offset:8192
    v_mfma_f32_16x16x32_bf16 v[208:211], a[20:23], a[64:67], 0
    ds_read_b64_tr_b16 a[62:63], v59 offset:9216
    v_mfma_f32_16x16x32_bf16 v[212:215], a[20:23], a[68:71], 0
    buffer_load_dwordx4 v7, s[24:27], s50 offen offset:1024 lds
    v_mfma_f32_16x16x32_bf16 v[216:219], a[20:23], a[72:75], 0
    v_mfma_f32_16x16x32_bf16 v[220:223], a[20:23], a[76:79], 0
    v_mfma_f32_16x16x32_bf16 v[224:227], a[24:27], a[64:67], 0
    buffer_load_dwordx4 v8, s[24:27], s50 offen offset:2048 lds
    v_mfma_f32_16x16x32_bf16 v[228:231], a[24:27], a[68:71], 0
    v_mfma_f32_16x16x32_bf16 v[232:235], a[24:27], a[72:75], 0
    v_mfma_f32_16x16x32_bf16 v[236:239], a[24:27], a[76:79], 0
    buffer_load_dwordx4 v9, s[24:27], s50 offen offset:3072 lds
    s_lshr_b64 s[82:83], s[82:83], 4
    s_and_b32 s50, s82, 15
    s_lshl_b32 s50, s50, 7
    v_mfma_f32_16x16x32_bf16 v[240:243], a[28:31], a[64:67], 0
    v_mfma_f32_16x16x32_bf16 v[244:247], a[28:31], a[68:71], 0
    v_mfma_f32_16x16x32_bf16 v[248:251], a[28:31], a[72:75], 0
    v_mfma_f32_16x16x32_bf16 v[252:255], a[28:31], a[76:79], 0
    s_waitcnt vmcnt(12) lgkmcnt(0)
    s_barrier
    v_mfma_f32_16x16x32_bf16 v[128:131], a[32:35], a[80:83], v[128:131]
    ds_read_b64_tr_b16 a[0:1], v52 offset:16384
    s_add_u32 m0, s49, 8192
    ds_read_b64_tr_b16 a[2:3], v52 offset:17408
    buffer_load_dwordx4 v10, s[28:31], s51 offen offset:0 lds
    v_mfma_f32_16x16x32_bf16 v[132:135], a[32:35], a[84:87], v[132:135]
    ds_read_b64_tr_b16 a[4:5], v53 offset:16384
    v_mfma_f32_16x16x32_bf16 v[136:139], a[32:35], a[88:91], v[136:139]
    ds_read_b64_tr_b16 a[6:7], v53 offset:17408
    v_mfma_f32_16x16x32_bf16 v[140:143], a[32:35], a[92:95], v[140:143]
    ds_read_b64_tr_b16 a[8:9], v54 offset:16384
    v_mfma_f32_16x16x32_bf16 v[144:147], a[36:39], a[80:83], v[144:147]
    ds_read_b64_tr_b16 a[10:11], v54 offset:17408
    v_mfma_f32_16x16x32_bf16 v[148:151], a[36:39], a[84:87], v[148:151]
    ds_read_b64_tr_b16 a[12:13], v55 offset:16384
    v_mfma_f32_16x16x32_bf16 v[152:155], a[36:39], a[88:91], v[152:155]
    ds_read_b64_tr_b16 a[14:15], v55 offset:17408
    v_mfma_f32_16x16x32_bf16 v[156:159], a[36:39], a[92:95], v[156:159]
    ds_read_b64_tr_b16 a[16:17], v56 offset:16384
    v_mfma_f32_16x16x32_bf16 v[160:163], a[40:43], a[80:83], v[160:163]
    ds_read_b64_tr_b16 a[18:19], v56 offset:17408
    v_mfma_f32_16x16x32_bf16 v[164:167], a[40:43], a[84:87], v[164:167]
    ds_read_b64_tr_b16 a[20:21], v57 offset:16384
    v_mfma_f32_16x16x32_bf16 v[168:171], a[40:43], a[88:91], v[168:171]
    ds_read_b64_tr_b16 a[22:23], v57 offset:17408
    v_mfma_f32_16x16x32_bf16 v[172:175], a[40:43], a[92:95], v[172:175]
    ds_read_b64_tr_b16 a[24:25], v58 offset:16384
    ds_read_b64_tr_b16 a[26:27], v58 offset:17408
    v_mfma_f32_16x16x32_bf16 v[176:179], a[44:47], a[80:83], v[176:179]
    ds_read_b64_tr_b16 a[28:29], v59 offset:16384
    v_mfma_f32_16x16x32_bf16 v[180:183], a[44:47], a[84:87], v[180:183]
    ds_read_b64_tr_b16 a[30:31], v59 offset:17408
    v_mfma_f32_16x16x32_bf16 v[184:187], a[44:47], a[88:91], v[184:187]
    ds_read_b128 a[96:99], v16 offset:24576
    v_mfma_f32_16x16x32_bf16 v[188:191], a[44:47], a[92:95], v[188:191]
    ds_read_b128 a[100:103], v16 offset:26624
    buffer_load_dwordx4 v11, s[28:31], s51 offen offset:1024 lds
    s_lshr_b64 s[84:85], s[84:85], 4
    s_and_b32 s51, s84, 15
    s_lshl_b32 s51, s51, 19
    v_mfma_f32_16x16x32_bf16 v[192:195], a[48:51], a[80:83], v[192:195]
    ds_read_b128 a[104:107], v16 offset:28672
    v_mfma_f32_16x16x32_bf16 v[196:199], a[48:51], a[84:87], v[196:199]
    ds_read_b128 a[108:111], v16 offset:30720
    v_mfma_f32_16x16x32_bf16 v[200:203], a[48:51], a[88:91], v[200:203]
    ds_read_b128 a[112:115], v17 offset:24576
    v_mfma_f32_16x16x32_bf16 v[204:207], a[48:51], a[92:95], v[204:207]
    ds_read_b128 a[116:119], v17 offset:26624
    v_mfma_f32_16x16x32_bf16 v[208:211], a[52:55], a[80:83], v[208:211]
    ds_read_b128 a[120:123], v17 offset:28672
    v_mfma_f32_16x16x32_bf16 v[212:215], a[52:55], a[84:87], v[212:215]
    ds_read_b128 a[124:127], v17 offset:30720
    v_mfma_f32_16x16x32_bf16 v[216:219], a[52:55], a[88:91], v[216:219]
    v_mfma_f32_16x16x32_bf16 v[220:223], a[52:55], a[92:95], v[220:223]
    v_mfma_f32_16x16x32_bf16 v[224:227], a[56:59], a[80:83], v[224:227]
    v_mfma_f32_16x16x32_bf16 v[228:231], a[56:59], a[84:87], v[228:231]
    v_mfma_f32_16x16x32_bf16 v[232:235], a[56:59], a[88:91], v[232:235]
    v_mfma_f32_16x16x32_bf16 v[236:239], a[56:59], a[92:95], v[236:239]
    v_mfma_f32_16x16x32_bf16 v[240:243], a[60:63], a[80:83], v[240:243]
    v_mfma_f32_16x16x32_bf16 v[244:247], a[60:63], a[84:87], v[244:247]
    v_mfma_f32_16x16x32_bf16 v[248:251], a[60:63], a[88:91], v[248:251]
    v_mfma_f32_16x16x32_bf16 v[252:255], a[60:63], a[92:95], v[252:255]
    s_waitcnt vmcnt(12) lgkmcnt(0)
    s_barrier
    v_mfma_f32_16x16x32_bf16 v[128:131], a[0:3], a[96:99], v[128:131]
    s_add_u32 m0, s48, 24576
    ds_read_b64_tr_b16 a[32:33], v52 offset:24576
    buffer_load_dwordx4 v2, s[24:27], s50 offen offset:0 lds
    v_mfma_f32_16x16x32_bf16 v[132:135], a[0:3], a[100:103], v[132:135]
    ds_read_b64_tr_b16 a[34:35], v52 offset:25600
    v_mfma_f32_16x16x32_bf16 v[136:139], a[0:3], a[104:107], v[136:139]
    ds_read_b64_tr_b16 a[36:37], v53 offset:24576
    v_mfma_f32_16x16x32_bf16 v[140:143], a[0:3], a[108:111], v[140:143]
    buffer_load_dwordx4 v3, s[24:27], s50 offen offset:1024 lds
    v_mfma_f32_16x16x32_bf16 v[144:147], a[4:7], a[96:99], v[144:147]
    ds_read_b64_tr_b16 a[38:39], v53 offset:25600
    v_mfma_f32_16x16x32_bf16 v[148:151], a[4:7], a[100:103], v[148:151]
    ds_read_b64_tr_b16 a[40:41], v54 offset:24576
    v_mfma_f32_16x16x32_bf16 v[152:155], a[4:7], a[104:107], v[152:155]
    s_add_u32 m0, s49, 16384
    ds_read_b64_tr_b16 a[42:43], v54 offset:25600
    buffer_load_dwordx4 v10, s[28:31], s51 offen offset:0 lds
    v_mfma_f32_16x16x32_bf16 v[156:159], a[4:7], a[108:111], v[156:159]
    v_mfma_f32_16x16x32_bf16 v[160:163], a[8:11], a[96:99], v[160:163]
    ds_read_b64_tr_b16 a[44:45], v55 offset:24576
    v_mfma_f32_16x16x32_bf16 v[164:167], a[8:11], a[100:103], v[164:167]
    s_add_u32 m0, s48, 24576
    ds_read_b64_tr_b16 a[46:47], v55 offset:25600
    buffer_load_dwordx4 v4, s[24:27], s50 offen offset:2048 lds
    v_mfma_f32_16x16x32_bf16 v[168:171], a[8:11], a[104:107], v[168:171]
    v_mfma_f32_16x16x32_bf16 v[172:175], a[8:11], a[108:111], v[172:175]
    ds_read_b64_tr_b16 a[48:49], v56 offset:24576
    v_mfma_f32_16x16x32_bf16 v[176:179], a[12:15], a[96:99], v[176:179]
    ds_read_b64_tr_b16 a[50:51], v56 offset:25600
    buffer_load_dwordx4 v5, s[24:27], s50 offen offset:3072 lds
    v_mfma_f32_16x16x32_bf16 v[180:183], a[12:15], a[100:103], v[180:183]
    ds_read_b64_tr_b16 a[52:53], v57 offset:24576
    v_mfma_f32_16x16x32_bf16 v[184:187], a[12:15], a[104:107], v[184:187]
    v_mfma_f32_16x16x32_bf16 v[188:191], a[12:15], a[108:111], v[188:191]
    s_add_u32 m0, s49, 16384
    ds_read_b64_tr_b16 a[54:55], v57 offset:25600
    buffer_load_dwordx4 v11, s[28:31], s51 offen offset:1024 lds
    s_add_u32 s51, s51, 262144
    v_mfma_f32_16x16x32_bf16 v[192:195], a[16:19], a[96:99], v[192:195]
    ds_read_b64_tr_b16 a[56:57], v58 offset:24576
    v_mfma_f32_16x16x32_bf16 v[196:199], a[16:19], a[100:103], v[196:199]
    ds_read_b64_tr_b16 a[58:59], v58 offset:25600
    s_add_u32 m0, s48, 28672
    v_mfma_f32_16x16x32_bf16 v[200:203], a[16:19], a[104:107], v[200:203]
    buffer_load_dwordx4 v6, s[24:27], s50 offen offset:0 lds
    v_mfma_f32_16x16x32_bf16 v[204:207], a[16:19], a[108:111], v[204:207]
    ds_read_b64_tr_b16 a[60:61], v59 offset:24576
    v_mfma_f32_16x16x32_bf16 v[208:211], a[20:23], a[96:99], v[208:211]
    ds_read_b64_tr_b16 a[62:63], v59 offset:25600
    v_mfma_f32_16x16x32_bf16 v[212:215], a[20:23], a[100:103], v[212:215]
    buffer_load_dwordx4 v7, s[24:27], s50 offen offset:1024 lds
    v_mfma_f32_16x16x32_bf16 v[216:219], a[20:23], a[104:107], v[216:219]
    v_mfma_f32_16x16x32_bf16 v[220:223], a[20:23], a[108:111], v[220:223]
    v_mfma_f32_16x16x32_bf16 v[224:227], a[24:27], a[96:99], v[224:227]
    buffer_load_dwordx4 v8, s[24:27], s50 offen offset:2048 lds
    v_mfma_f32_16x16x32_bf16 v[228:231], a[24:27], a[100:103], v[228:231]
    v_mfma_f32_16x16x32_bf16 v[232:235], a[24:27], a[104:107], v[232:235]
    v_mfma_f32_16x16x32_bf16 v[236:239], a[24:27], a[108:111], v[236:239]
    buffer_load_dwordx4 v9, s[24:27], s50 offen offset:3072 lds
    s_lshr_b64 s[82:83], s[82:83], 4
    s_and_b32 s50, s82, 15
    s_lshl_b32 s50, s50, 7
    v_mfma_f32_16x16x32_bf16 v[240:243], a[28:31], a[96:99], v[240:243]
    v_mfma_f32_16x16x32_bf16 v[244:247], a[28:31], a[100:103], v[244:247]
    v_mfma_f32_16x16x32_bf16 v[248:251], a[28:31], a[104:107], v[248:251]
    v_mfma_f32_16x16x32_bf16 v[252:255], a[28:31], a[108:111], v[252:255]
    s_waitcnt vmcnt(12) lgkmcnt(0)
    s_barrier
    v_mfma_f32_16x16x32_bf16 v[128:131], a[32:35], a[112:115], v[128:131]
    ds_read_b64_tr_b16 a[0:1], v52 offset:0
    s_add_u32 m0, s49, 24576
    ds_read_b64_tr_b16 a[2:3], v52 offset:1024
    buffer_load_dwordx4 v10, s[28:31], s51 offen offset:0 lds
    v_mfma_f32_16x16x32_bf16 v[132:135], a[32:35], a[116:119], v[132:135]
    ds_read_b64_tr_b16 a[4:5], v53 offset:0
    v_mfma_f32_16x16x32_bf16 v[136:139], a[32:35], a[120:123], v[136:139]
    ds_read_b64_tr_b16 a[6:7], v53 offset:1024
    v_mfma_f32_16x16x32_bf16 v[140:143], a[32:35], a[124:127], v[140:143]
    ds_read_b64_tr_b16 a[8:9], v54 offset:0
    v_mfma_f32_16x16x32_bf16 v[144:147], a[36:39], a[112:115], v[144:147]
    ds_read_b64_tr_b16 a[10:11], v54 offset:1024
    v_mfma_f32_16x16x32_bf16 v[148:151], a[36:39], a[116:119], v[148:151]
    ds_read_b64_tr_b16 a[12:13], v55 offset:0
    v_mfma_f32_16x16x32_bf16 v[152:155], a[36:39], a[120:123], v[152:155]
    ds_read_b64_tr_b16 a[14:15], v55 offset:1024
    v_mfma_f32_16x16x32_bf16 v[156:159], a[36:39], a[124:127], v[156:159]
    ds_read_b64_tr_b16 a[16:17], v56 offset:0
    v_mfma_f32_16x16x32_bf16 v[160:163], a[40:43], a[112:115], v[160:163]
    ds_read_b64_tr_b16 a[18:19], v56 offset:1024
    v_mfma_f32_16x16x32_bf16 v[164:167], a[40:43], a[116:119], v[164:167]
    ds_read_b64_tr_b16 a[20:21], v57 offset:0
    v_mfma_f32_16x16x32_bf16 v[168:171], a[40:43], a[120:123], v[168:171]
    ds_read_b64_tr_b16 a[22:23], v57 offset:1024
    v_mfma_f32_16x16x32_bf16 v[172:175], a[40:43], a[124:127], v[172:175]
    ds_read_b64_tr_b16 a[24:25], v58 offset:0
    ds_read_b64_tr_b16 a[26:27], v58 offset:1024
    v_mfma_f32_16x16x32_bf16 v[176:179], a[44:47], a[112:115], v[176:179]
    ds_read_b64_tr_b16 a[28:29], v59 offset:0
    v_mfma_f32_16x16x32_bf16 v[180:183], a[44:47], a[116:119], v[180:183]
    ds_read_b64_tr_b16 a[30:31], v59 offset:1024
    v_mfma_f32_16x16x32_bf16 v[184:187], a[44:47], a[120:123], v[184:187]
    ds_read_b128 a[64:67], v16 offset:16384
    v_mfma_f32_16x16x32_bf16 v[188:191], a[44:47], a[124:127], v[188:191]
    ds_read_b128 a[68:71], v16 offset:18432
    buffer_load_dwordx4 v11, s[28:31], s51 offen offset:1024 lds
    s_lshr_b64 s[84:85], s[84:85], 4
    s_and_b32 s51, s84, 15
    s_lshl_b32 s51, s51, 19
    v_mfma_f32_16x16x32_bf16 v[192:195], a[48:51], a[112:115], v[192:195]
    ds_read_b128 a[72:75], v16 offset:20480
    v_mfma_f32_16x16x32_bf16 v[196:199], a[48:51], a[116:119], v[196:199]
    ds_read_b128 a[76:79], v16 offset:22528
    v_mfma_f32_16x16x32_bf16 v[200:203], a[48:51], a[120:123], v[200:203]
    ds_read_b128 a[80:83], v17 offset:16384
    v_mfma_f32_16x16x32_bf16 v[204:207], a[48:51], a[124:127], v[204:207]
    ds_read_b128 a[84:87], v17 offset:18432
    v_mfma_f32_16x16x32_bf16 v[208:211], a[52:55], a[112:115], v[208:211]
    ds_read_b128 a[88:91], v17 offset:20480
    v_mfma_f32_16x16x32_bf16 v[212:215], a[52:55], a[116:119], v[212:215]
    ds_read_b128 a[92:95], v17 offset:22528
    v_mfma_f32_16x16x32_bf16 v[216:219], a[52:55], a[120:123], v[216:219]
    v_mfma_f32_16x16x32_bf16 v[220:223], a[52:55], a[124:127], v[220:223]
    v_mfma_f32_16x16x32_bf16 v[224:227], a[56:59], a[112:115], v[224:227]
    v_mfma_f32_16x16x32_bf16 v[228:231], a[56:59], a[116:119], v[228:231]
    v_mfma_f32_16x16x32_bf16 v[232:235], a[56:59], a[120:123], v[232:235]
    v_mfma_f32_16x16x32_bf16 v[236:239], a[56:59], a[124:127], v[236:239]
    v_mfma_f32_16x16x32_bf16 v[240:243], a[60:63], a[112:115], v[240:243]
    v_mfma_f32_16x16x32_bf16 v[244:247], a[60:63], a[116:119], v[244:247]
    v_mfma_f32_16x16x32_bf16 v[248:251], a[60:63], a[120:123], v[248:251]
    v_mfma_f32_16x16x32_bf16 v[252:255], a[60:63], a[124:127], v[252:255]
    s_mov_b32 s54, 0
L1_p1loop:
    s_waitcnt vmcnt(12) lgkmcnt(0)
    s_barrier
    v_mfma_f32_16x16x32_bf16 v[128:131], a[0:3], a[64:67], v[128:131]
    s_add_u32 m0, s48, 16384
    ds_read_b64_tr_b16 a[32:33], v52 offset:8192
    buffer_load_dwordx4 v2, s[24:27], s50 offen offset:0 lds
    v_mfma_f32_16x16x32_bf16 v[132:135], a[0:3], a[68:71], v[132:135]
    ds_read_b64_tr_b16 a[34:35], v52 offset:9216
    v_mfma_f32_16x16x32_bf16 v[136:139], a[0:3], a[72:75], v[136:139]
    ds_read_b64_tr_b16 a[36:37], v53 offset:8192
    v_mfma_f32_16x16x32_bf16 v[140:143], a[0:3], a[76:79], v[140:143]
    buffer_load_dwordx4 v3, s[24:27], s50 offen offset:1024 lds
    v_mfma_f32_16x16x32_bf16 v[144:147], a[4:7], a[64:67], v[144:147]
    ds_read_b64_tr_b16 a[38:39], v53 offset:9216
    v_mfma_f32_16x16x32_bf16 v[148:151], a[4:7], a[68:71], v[148:151]
    ds_read_b64_tr_b16 a[40:41], v54 offset:8192
    v_mfma_f32_16x16x32_bf16 v[152:155], a[4:7], a[72:75], v[152:155]
    s_add_u32 m0, s49, 0
    ds_read_b64_tr_b16 a[42:43], v54 offset:9216
    buffer_load_dwordx4 v10, s[28:31], s51 offen offset:0 lds
    v_mfma_f32_16x16x32_bf16 v[156:159], a[4:7], a[76:79], v[156:159]
    v_mfma_f32_16x16x32_bf16 v[160:163], a[8:11], a[64:67], v[160:163]
    ds_read_b64_tr_b16 a[44:45], v55 offset:8192
    v_mfma_f32_16x16x32_bf16 v[164:167], a[8:11], a[68:71], v[164:167]
    s_add_u32 m0, s48, 16384
    ds_read_b64_tr_b16 a[46:47], v55 offset:9216
    buffer_load_dwordx4 v4, s[24:27], s50 offen offset:2048 lds
    v_mfma_f32_16x16x32_bf16 v[168:171], a[8:11], a[72:75], v[168:171]
    v_mfma_f32_16x16x32_bf16 v[172:175], a[8:11], a[76:79], v[172:175]
    ds_read_b64_tr_b16 a[48:49], v56 offset:8192
    v_mfma_f32_16x16x32_bf16 v[176:179], a[12:15], a[64:67], v[176:179]
    ds_read_b64_tr_b16 a[50:51], v56 offset:9216
    buffer_load_dwordx4 v5, s[24:27], s50 offen offset:3072 lds
    v_mfma_f32_16x16x32_bf16 v[180:183], a[12:15], a[68:71], v[180:183]
    ds_read_b64_tr_b16 a[52:53], v57 offset:8192
    v_mfma_f32_16x16x32_bf16 v[184:187], a[12:15], a[72:75], v[184:187]
    v_mfma_f32_16x16x32_bf16 v[188:191], a[12:15], a[76:79], v[188:191]
    s_add_u32 m0, s49, 0
    ds_read_b64_tr_b16 a[54:55], v57 offset:9216
    buffer_load_dwordx4 v11, s[28:31], s51 offen offset:1024 lds
    s_add_u32 s51, s51, 262144
    v_mfma_f32_16x16x32_bf16 v[192:195], a[16:19], a[64:67], v[192:195]
    ds_read_b64_tr_b16 a[56:57], v58 offset:8192
    v_mfma_f32_16x16x32_bf16 v[196:199], a[16:19], a[68:71], v[196:199]
    ds_read_b64_tr_b16 a[58:59], v58 offset:9216
    s_add_u32 m0, s48, 20480
    v_mfma_f32_16x16x32_bf16 v[200:203], a[16:19], a[72:75], v[200:203]
    buffer_load_dwordx4 v6, s[24:27], s50 offen offset:0 lds
    v_mfma_f32_16x16x32_bf16 v[204:207], a[16:19], a[76:79], v[204:207]
    ds_read_b64_tr_b16 a[60:61], v59 offset:8192
    v_mfma_f32_16x16x32_bf16 v[208:211], a[20:23], a[64:67], v[208:211]
    ds_read_b64_tr_b16 a[62:63], v59 offset:9216
    v_mfma_f32_16x16x32_bf16 v[212:215], a[20:23], a[68:71], v[212:215]
    buffer_load_dwordx4 v7, s[24:27], s50 offen offset:1024 lds
    v_mfma_f32_16x16x32_bf16 v[216:219], a[20:23], a[72:75], v[216:219]
    v_mfma_f32_16x16x32_bf16 v[220:223], a[20:23], a[76:79], v[220:223]
    v_mfma_f32_16x16x32_bf16 v[224:227], a[24:27], a[64:67], v[224:227]
    buffer_load_dwordx4 v8, s[24:27], s50 offen offset:2048 lds
    v_mfma_f32_16x16x32_bf16 v[228:231], a[24:27], a[68:71], v[228:231]
    v_mfma_f32_16x16x32_bf16 v[232:235], a[24:27], a[72:75], v[232:235]
    v_mfma_f32_16x16x32_bf16 v[236:239], a[24:27], a[76:79], v[236:239]
    buffer_load_dwordx4 v9, s[24:27], s50 offen offset:3072 lds
    s_lshr_b64 s[82:83], s[82:83], 4
    s_and_b32 s50, s82, 15
    s_lshl_b32 s50, s50, 7
    v_mfma_f32_16x16x32_bf16 v[240:243], a[28:31], a[64:67], v[240:243]
    v_mfma_f32_16x16x32_bf16 v[244:247], a[28:31], a[68:71], v[244:247]
    v_mfma_f32_16x16x32_bf16 v[248:251], a[28:31], a[72:75], v[248:251]
    v_mfma_f32_16x16x32_bf16 v[252:255], a[28:31], a[76:79], v[252:255]
    s_waitcnt vmcnt(12) lgkmcnt(0)
    s_barrier
    v_mfma_f32_16x16x32_bf16 v[128:131], a[32:35], a[80:83], v[128:131]
    ds_read_b64_tr_b16 a[0:1], v52 offset:16384
    s_add_u32 m0, s49, 8192
    ds_read_b64_tr_b16 a[2:3], v52 offset:17408
    buffer_load_dwordx4 v10, s[28:31], s51 offen offset:0 lds
    v_mfma_f32_16x16x32_bf16 v[132:135], a[32:35], a[84:87], v[132:135]
    ds_read_b64_tr_b16 a[4:5], v53 offset:16384
    v_mfma_f32_16x16x32_bf16 v[136:139], a[32:35], a[88:91], v[136:139]
    ds_read_b64_tr_b16 a[6:7], v53 offset:17408
    v_mfma_f32_16x16x32_bf16 v[140:143], a[32:35], a[92:95], v[140:143]
    ds_read_b64_tr_b16 a[8:9], v54 offset:16384
    v_mfma_f32_16x16x32_bf16 v[144:147], a[36:39], a[80:83], v[144:147]
    ds_read_b64_tr_b16 a[10:11], v54 offset:17408
    v_mfma_f32_16x16x32_bf16 v[148:151], a[36:39], a[84:87], v[148:151]
    ds_read_b64_tr_b16 a[12:13], v55 offset:16384
    v_mfma_f32_16x16x32_bf16 v[152:155], a[36:39], a[88:91], v[152:155]
    ds_read_b64_tr_b16 a[14:15], v55 offset:17408
    v_mfma_f32_16x16x32_bf16 v[156:159], a[36:39], a[92:95], v[156:159]
    ds_read_b64_tr_b16 a[16:17], v56 offset:16384
    v_mfma_f32_16x16x32_bf16 v[160:163], a[40:43], a[80:83], v[160:163]
    ds_read_b64_tr_b16 a[18:19], v56 offset:17408
    v_mfma_f32_16x16x32_bf16 v[164:167], a[40:43], a[84:87], v[164:167]
    ds_read_b64_tr_b16 a[20:21], v57 offset:16384
    v_mfma_f32_16x16x32_bf16 v[168:171], a[40:43], a[88:91], v[168:171]
    ds_read_b64_tr_b16 a[22:23], v57 offset:17408
    v_mfma_f32_16x16x32_bf16 v[172:175], a[40:43], a[92:95], v[172:175]
    ds_read_b64_tr_b16 a[24:25], v58 offset:16384
    ds_read_b64_tr_b16 a[26:27], v58 offset:17408
    v_mfma_f32_16x16x32_bf16 v[176:179], a[44:47], a[80:83], v[176:179]
    ds_read_b64_tr_b16 a[28:29], v59 offset:16384
    v_mfma_f32_16x16x32_bf16 v[180:183], a[44:47], a[84:87], v[180:183]
    ds_read_b64_tr_b16 a[30:31], v59 offset:17408
    v_mfma_f32_16x16x32_bf16 v[184:187], a[44:47], a[88:91], v[184:187]
    ds_read_b128 a[96:99], v16 offset:24576
    v_mfma_f32_16x16x32_bf16 v[188:191], a[44:47], a[92:95], v[188:191]
    ds_read_b128 a[100:103], v16 offset:26624
    buffer_load_dwordx4 v11, s[28:31], s51 offen offset:1024 lds
    s_lshr_b64 s[84:85], s[84:85], 4
    s_and_b32 s51, s84, 15
    s_lshl_b32 s51, s51, 19
    v_mfma_f32_16x16x32_bf16 v[192:195], a[48:51], a[80:83], v[192:195]
    ds_read_b128 a[104:107], v16 offset:28672
    v_mfma_f32_16x16x32_bf16 v[196:199], a[48:51], a[84:87], v[196:199]
    ds_read_b128 a[108:111], v16 offset:30720
    v_mfma_f32_16x16x32_bf16 v[200:203], a[48:51], a[88:91], v[200:203]
    ds_read_b128 a[112:115], v17 offset:24576
    v_mfma_f32_16x16x32_bf16 v[204:207], a[48:51], a[92:95], v[204:207]
    ds_read_b128 a[116:119], v17 offset:26624
    v_mfma_f32_16x16x32_bf16 v[208:211], a[52:55], a[80:83], v[208:211]
    ds_read_b128 a[120:123], v17 offset:28672
    v_mfma_f32_16x16x32_bf16 v[212:215], a[52:55], a[84:87], v[212:215]
    ds_read_b128 a[124:127], v17 offset:30720
    v_mfma_f32_16x16x32_bf16 v[216:219], a[52:55], a[88:91], v[216:219]
    v_mfma_f32_16x16x32_bf16 v[220:223], a[52:55], a[92:95], v[220:223]
    v_mfma_f32_16x16x32_bf16 v[224:227], a[56:59], a[80:83], v[224:227]
    v_mfma_f32_16x16x32_bf16 v[228:231], a[56:59], a[84:87], v[228:231]
    v_mfma_f32_16x16x32_bf16 v[232:235], a[56:59], a[88:91], v[232:235]
    v_mfma_f32_16x16x32_bf16 v[236:239], a[56:59], a[92:95], v[236:239]
    v_mfma_f32_16x16x32_bf16 v[240:243], a[60:63], a[80:83], v[240:243]
    v_mfma_f32_16x16x32_bf16 v[244:247], a[60:63], a[84:87], v[244:247]
    v_mfma_f32_16x16x32_bf16 v[248:251], a[60:63], a[88:91], v[248:251]
    v_mfma_f32_16x16x32_bf16 v[252:255], a[60:63], a[92:95], v[252:255]
    s_waitcnt vmcnt(12) lgkmcnt(0)
    s_barrier
    v_mfma_f32_16x16x32_bf16 v[128:131], a[0:3], a[96:99], v[128:131]
    s_add_u32 m0, s48, 24576
    ds_read_b64_tr_b16 a[32:33], v52 offset:24576
    buffer_load_dwordx4 v2, s[24:27], s50 offen offset:0 lds
    v_mfma_f32_16x16x32_bf16 v[132:135], a[0:3], a[100:103], v[132:135]
    ds_read_b64_tr_b16 a[34:35], v52 offset:25600
    v_mfma_f32_16x16x32_bf16 v[136:139], a[0:3], a[104:107], v[136:139]
    ds_read_b64_tr_b16 a[36:37], v53 offset:24576
    v_mfma_f32_16x16x32_bf16 v[140:143], a[0:3], a[108:111], v[140:143]
    buffer_load_dwordx4 v3, s[24:27], s50 offen offset:1024 lds
    v_mfma_f32_16x16x32_bf16 v[144:147], a[4:7], a[96:99], v[144:147]
    ds_read_b64_tr_b16 a[38:39], v53 offset:25600
    v_mfma_f32_16x16x32_bf16 v[148:151], a[4:7], a[100:103], v[148:151]
    ds_read_b64_tr_b16 a[40:41], v54 offset:24576
    v_mfma_f32_16x16x32_bf16 v[152:155], a[4:7], a[104:107], v[152:155]
    s_add_u32 m0, s49, 16384
    ds_read_b64_tr_b16 a[42:43], v54 offset:25600
    buffer_load_dwordx4 v10, s[28:31], s51 offen offset:0 lds
    v_mfma_f32_16x16x32_bf16 v[156:159], a[4:7], a[108:111], v[156:159]
    v_mfma_f32_16x16x32_bf16 v[160:163], a[8:11], a[96:99], v[160:163]
    ds_read_b64_tr_b16 a[44:45], v55 offset:24576
    v_mfma_f32_16x16x32_bf16 v[164:167], a[8:11], a[100:103], v[164:167]
    s_add_u32 m0, s48, 24576
    ds_read_b64_tr_b16 a[46:47], v55 offset:25600
    buffer_load_dwordx4 v4, s[24:27], s50 offen offset:2048 lds
    v_mfma_f32_16x16x32_bf16 v[168:171], a[8:11], a[104:107], v[168:171]
    v_mfma_f32_16x16x32_bf16 v[172:175], a[8:11], a[108:111], v[172:175]
    ds_read_b64_tr_b16 a[48:49], v56 offset:24576
    v_mfma_f32_16x16x32_bf16 v[176:179], a[12:15], a[96:99], v[176:179]
    ds_read_b64_tr_b16 a[50:51], v56 offset:25600
    buffer_load_dwordx4 v5, s[24:27], s50 offen offset:3072 lds
    v_mfma_f32_16x16x32_bf16 v[180:183], a[12:15], a[100:103], v[180:183]
    ds_read_b64_tr_b16 a[52:53], v57 offset:24576
    v_mfma_f32_16x16x32_bf16 v[184:187], a[12:15], a[104:107], v[184:187]
    v_mfma_f32_16x16x32_bf16 v[188:191], a[12:15], a[108:111], v[188:191]
    s_add_u32 m0, s49, 16384
    ds_read_b64_tr_b16 a[54:55], v57 offset:25600
    buffer_load_dwordx4 v11, s[28:31], s51 offen offset:1024 lds
    s_add_u32 s51, s51, 262144
    v_mfma_f32_16x16x32_bf16 v[192:195], a[16:19], a[96:99], v[192:195]
    ds_read_b64_tr_b16 a[56:57], v58 offset:24576
    v_mfma_f32_16x16x32_bf16 v[196:199], a[16:19], a[100:103], v[196:199]
    ds_read_b64_tr_b16 a[58:59], v58 offset:25600
    s_add_u32 m0, s48, 28672
    v_mfma_f32_16x16x32_bf16 v[200:203], a[16:19], a[104:107], v[200:203]
    buffer_load_dwordx4 v6, s[24:27], s50 offen offset:0 lds
    v_mfma_f32_16x16x32_bf16 v[204:207], a[16:19], a[108:111], v[204:207]
    ds_read_b64_tr_b16 a[60:61], v59 offset:24576
    v_mfma_f32_16x16x32_bf16 v[208:211], a[20:23], a[96:99], v[208:211]
    ds_read_b64_tr_b16 a[62:63], v59 offset:25600
    v_mfma_f32_16x16x32_bf16 v[212:215], a[20:23], a[100:103], v[212:215]
    buffer_load_dwordx4 v7, s[24:27], s50 offen offset:1024 lds
    v_mfma_f32_16x16x32_bf16 v[216:219], a[20:23], a[104:107], v[216:219]
    v_mfma_f32_16x16x32_bf16 v[220:223], a[20:23], a[108:111], v[220:223]
    v_mfma_f32_16x16x32_bf16 v[224:227], a[24:27], a[96:99], v[224:227]
    buffer_load_dwordx4 v8, s[24:27], s50 offen offset:2048 lds
    v_mfma_f32_16x16x32_bf16 v[228:231], a[24:27], a[100:103], v[228:231]
    v_mfma_f32_16x16x32_bf16 v[232:235], a[24:27], a[104:107], v[232:235]
    v_mfma_f32_16x16x32_bf16 v[236:239], a[24:27], a[108:111], v[236:239]
    buffer_load_dwordx4 v9, s[24:27], s50 offen offset:3072 lds
    s_lshr_b64 s[82:83], s[82:83], 4
    s_and_b32 s50, s82, 15
    s_lshl_b32 s50, s50, 7
    v_mfma_f32_16x16x32_bf16 v[240:243], a[28:31], a[96:99], v[240:243]
    v_mfma_f32_16x16x32_bf16 v[244:247], a[28:31], a[100:103], v[244:247]
    v_mfma_f32_16x16x32_bf16 v[248:251], a[28:31], a[104:107], v[248:251]
    v_mfma_f32_16x16x32_bf16 v[252:255], a[28:31], a[108:111], v[252:255]
    s_waitcnt vmcnt(12) lgkmcnt(0)
    s_barrier
    v_mfma_f32_16x16x32_bf16 v[128:131], a[32:35], a[112:115], v[128:131]
    ds_read_b64_tr_b16 a[0:1], v52 offset:0
    s_add_u32 m0, s49, 24576
    ds_read_b64_tr_b16 a[2:3], v52 offset:1024
    buffer_load_dwordx4 v10, s[28:31], s51 offen offset:0 lds
    v_mfma_f32_16x16x32_bf16 v[132:135], a[32:35], a[116:119], v[132:135]
    ds_read_b64_tr_b16 a[4:5], v53 offset:0
    v_mfma_f32_16x16x32_bf16 v[136:139], a[32:35], a[120:123], v[136:139]
    ds_read_b64_tr_b16 a[6:7], v53 offset:1024
    v_mfma_f32_16x16x32_bf16 v[140:143], a[32:35], a[124:127], v[140:143]
    ds_read_b64_tr_b16 a[8:9], v54 offset:0
    v_mfma_f32_16x16x32_bf16 v[144:147], a[36:39], a[112:115], v[144:147]
    ds_read_b64_tr_b16 a[10:11], v54 offset:1024
    v_mfma_f32_16x16x32_bf16 v[148:151], a[36:39], a[116:119], v[148:151]
    ds_read_b64_tr_b16 a[12:13], v55 offset:0
    v_mfma_f32_16x16x32_bf16 v[152:155], a[36:39], a[120:123], v[152:155]
    ds_read_b64_tr_b16 a[14:15], v55 offset:1024
    v_mfma_f32_16x16x32_bf16 v[156:159], a[36:39], a[124:127], v[156:159]
    ds_read_b64_tr_b16 a[16:17], v56 offset:0
    v_mfma_f32_16x16x32_bf16 v[160:163], a[40:43], a[112:115], v[160:163]
    ds_read_b64_tr_b16 a[18:19], v56 offset:1024
    v_mfma_f32_16x16x32_bf16 v[164:167], a[40:43], a[116:119], v[164:167]
    ds_read_b64_tr_b16 a[20:21], v57 offset:0
    v_mfma_f32_16x16x32_bf16 v[168:171], a[40:43], a[120:123], v[168:171]
    ds_read_b64_tr_b16 a[22:23], v57 offset:1024
    v_mfma_f32_16x16x32_bf16 v[172:175], a[40:43], a[124:127], v[172:175]
    ds_read_b64_tr_b16 a[24:25], v58 offset:0
    ds_read_b64_tr_b16 a[26:27], v58 offset:1024
    v_mfma_f32_16x16x32_bf16 v[176:179], a[44:47], a[112:115], v[176:179]
    ds_read_b64_tr_b16 a[28:29], v59 offset:0
    v_mfma_f32_16x16x32_bf16 v[180:183], a[44:47], a[116:119], v[180:183]
    ds_read_b64_tr_b16 a[30:31], v59 offset:1024
    v_mfma_f32_16x16x32_bf16 v[184:187], a[44:47], a[120:123], v[184:187]
    ds_read_b128 a[64:67], v16 offset:16384
    v_mfma_f32_16x16x32_bf16 v[188:191], a[44:47], a[124:127], v[188:191]
    ds_read_b128 a[68:71], v16 offset:18432
    buffer_load_dwordx4 v11, s[28:31], s51 offen offset:1024 lds
    s_lshr_b64 s[84:85], s[84:85], 4
    s_and_b32 s51, s84, 15
    s_lshl_b32 s51, s51, 19
    v_mfma_f32_16x16x32_bf16 v[192:195], a[48:51], a[112:115], v[192:195]
    ds_read_b128 a[72:75], v16 offset:20480
    v_mfma_f32_16x16x32_bf16 v[196:199], a[48:51], a[116:119], v[196:199]
    ds_read_b128 a[76:79], v16 offset:22528
    v_mfma_f32_16x16x32_bf16 v[200:203], a[48:51], a[120:123], v[200:203]
    ds_read_b128 a[80:83], v17 offset:16384
    v_mfma_f32_16x16x32_bf16 v[204:207], a[48:51], a[124:127], v[204:207]
    ds_read_b128 a[84:87], v17 offset:18432
    v_mfma_f32_16x16x32_bf16 v[208:211], a[52:55], a[112:115], v[208:211]
    ds_read_b128 a[88:91], v17 offset:20480
    v_mfma_f32_16x16x32_bf16 v[212:215], a[52:55], a[116:119], v[212:215]
    ds_read_b128 a[92:95], v17 offset:22528
    v_mfma_f32_16x16x32_bf16 v[216:219], a[52:55], a[120:123], v[216:219]
    v_mfma_f32_16x16x32_bf16 v[220:223], a[52:55], a[124:127], v[220:223]
    v_mfma_f32_16x16x32_bf16 v[224:227], a[56:59], a[112:115], v[224:227]
    v_mfma_f32_16x16x32_bf16 v[228:231], a[56:59], a[116:119], v[228:231]
    v_mfma_f32_16x16x32_bf16 v[232:235], a[56:59], a[120:123], v[232:235]
    v_mfma_f32_16x16x32_bf16 v[236:239], a[56:59], a[124:127], v[236:239]
    v_mfma_f32_16x16x32_bf16 v[240:243], a[60:63], a[112:115], v[240:243]
    v_mfma_f32_16x16x32_bf16 v[244:247], a[60:63], a[116:119], v[244:247]
    v_mfma_f32_16x16x32_bf16 v[248:251], a[60:63], a[120:123], v[248:251]
    v_mfma_f32_16x16x32_bf16 v[252:255], a[60:63], a[124:127], v[252:255]
    s_waitcnt vmcnt(12) lgkmcnt(0)
    s_barrier
    v_mfma_f32_16x16x32_bf16 v[128:131], a[0:3], a[64:67], v[128:131]
    s_add_u32 m0, s48, 16384
    ds_read_b64_tr_b16 a[32:33], v52 offset:8192
    buffer_load_dwordx4 v2, s[24:27], s50 offen offset:0 lds
    v_mfma_f32_16x16x32_bf16 v[132:135], a[0:3], a[68:71], v[132:135]
    ds_read_b64_tr_b16 a[34:35], v52 offset:9216
    v_mfma_f32_16x16x32_bf16 v[136:139], a[0:3], a[72:75], v[136:139]
    ds_read_b64_tr_b16 a[36:37], v53 offset:8192
    v_mfma_f32_16x16x32_bf16 v[140:143], a[0:3], a[76:79], v[140:143]
    buffer_load_dwordx4 v3, s[24:27], s50 offen offset:1024 lds
    v_mfma_f32_16x16x32_bf16 v[144:147], a[4:7], a[64:67], v[144:147]
    ds_read_b64_tr_b16 a[38:39], v53 offset:9216
    v_mfma_f32_16x16x32_bf16 v[148:151], a[4:7], a[68:71], v[148:151]
    ds_read_b64_tr_b16 a[40:41], v54 offset:8192
    v_mfma_f32_16x16x32_bf16 v[152:155], a[4:7], a[72:75], v[152:155]
    s_add_u32 m0, s49, 0
    ds_read_b64_tr_b16 a[42:43], v54 offset:9216
    buffer_load_dwordx4 v10, s[28:31], s51 offen offset:0 lds
    v_mfma_f32_16x16x32_bf16 v[156:159], a[4:7], a[76:79], v[156:159]
    v_mfma_f32_16x16x32_bf16 v[160:163], a[8:11], a[64:67], v[160:163]
    ds_read_b64_tr_b16 a[44:45], v55 offset:8192
    v_mfma_f32_16x16x32_bf16 v[164:167], a[8:11], a[68:71], v[164:167]
    s_add_u32 m0, s48, 16384
    ds_read_b64_tr_b16 a[46:47], v55 offset:9216
    buffer_load_dwordx4 v4, s[24:27], s50 offen offset:2048 lds
    v_mfma_f32_16x16x32_bf16 v[168:171], a[8:11], a[72:75], v[168:171]
    v_mfma_f32_16x16x32_bf16 v[172:175], a[8:11], a[76:79], v[172:175]
    ds_read_b64_tr_b16 a[48:49], v56 offset:8192
    v_mfma_f32_16x16x32_bf16 v[176:179], a[12:15], a[64:67], v[176:179]
    ds_read_b64_tr_b16 a[50:51], v56 offset:9216
    buffer_load_dwordx4 v5, s[24:27], s50 offen offset:3072 lds
    v_mfma_f32_16x16x32_bf16 v[180:183], a[12:15], a[68:71], v[180:183]
    ds_read_b64_tr_b16 a[52:53], v57 offset:8192
    v_mfma_f32_16x16x32_bf16 v[184:187], a[12:15], a[72:75], v[184:187]
    v_mfma_f32_16x16x32_bf16 v[188:191], a[12:15], a[76:79], v[188:191]
    s_add_u32 m0, s49, 0
    ds_read_b64_tr_b16 a[54:55], v57 offset:9216
    buffer_load_dwordx4 v11, s[28:31], s51 offen offset:1024 lds
    s_add_u32 s51, s51, 262144
    v_mfma_f32_16x16x32_bf16 v[192:195], a[16:19], a[64:67], v[192:195]
    ds_read_b64_tr_b16 a[56:57], v58 offset:8192
    v_mfma_f32_16x16x32_bf16 v[196:199], a[16:19], a[68:71], v[196:199]
    ds_read_b64_tr_b16 a[58:59], v58 offset:9216
    s_add_u32 m0, s48, 20480
    v_mfma_f32_16x16x32_bf16 v[200:203], a[16:19], a[72:75], v[200:203]
    buffer_load_dwordx4 v6, s[24:27], s50 offen offset:0 lds
    v_mfma_f32_16x16x32_bf16 v[204:207], a[16:19], a[76:79], v[204:207]
    ds_read_b64_tr_b16 a[60:61], v59 offset:8192
    v_mfma_f32_16x16x32_bf16 v[208:211], a[20:23], a[64:67], v[208:211]
    ds_read_b64_tr_b16 a[62:63], v59 offset:9216
    v_mfma_f32_16x16x32_bf16 v[212:215], a[20:23], a[68:71], v[212:215]
    buffer_load_dwordx4 v7, s[24:27], s50 offen offset:1024 lds
    v_mfma_f32_16x16x32_bf16 v[216:219], a[20:23], a[72:75], v[216:219]
    v_mfma_f32_16x16x32_bf16 v[220:223], a[20:23], a[76:79], v[220:223]
    v_mfma_f32_16x16x32_bf16 v[224:227], a[24:27], a[64:67], v[224:227]
    buffer_load_dwordx4 v8, s[24:27], s50 offen offset:2048 lds
    v_mfma_f32_16x16x32_bf16 v[228:231], a[24:27], a[68:71], v[228:231]
    v_mfma_f32_16x16x32_bf16 v[232:235], a[24:27], a[72:75], v[232:235]
    v_mfma_f32_16x16x32_bf16 v[236:239], a[24:27], a[76:79], v[236:239]
    buffer_load_dwordx4 v9, s[24:27], s50 offen offset:3072 lds
    s_lshr_b64 s[82:83], s[82:83], 4
    s_and_b32 s50, s82, 15
    s_lshl_b32 s50, s50, 7
    v_mfma_f32_16x16x32_bf16 v[240:243], a[28:31], a[64:67], v[240:243]
    v_mfma_f32_16x16x32_bf16 v[244:247], a[28:31], a[68:71], v[244:247]
    v_mfma_f32_16x16x32_bf16 v[248:251], a[28:31], a[72:75], v[248:251]
    v_mfma_f32_16x16x32_bf16 v[252:255], a[28:31], a[76:79], v[252:255]
    s_waitcnt vmcnt(12) lgkmcnt(0)
    s_barrier
    v_mfma_f32_16x16x32_bf16 v[128:131], a[32:35], a[80:83], v[128:131]
    ds_read_b64_tr_b16 a[0:1], v52 offset:16384
    s_add_u32 m0, s49, 8192
    ds_read_b64_tr_b16 a[2:3], v52 offset:17408
    buffer_load_dwordx4 v10, s[28:31], s51 offen offset:0 lds
    v_mfma_f32_16x16x32_bf16 v[132:135], a[32:35], a[84:87], v[132:135]
    ds_read_b64_tr_b16 a[4:5], v53 offset:16384
    v_mfma_f32_16x16x32_bf16 v[136:139], a[32:35], a[88:91], v[136:139]
    ds_read_b64_tr_b16 a[6:7], v53 offset:17408
    v_mfma_f32_16x16x32_bf16 v[140:143], a[32:35], a[92:95], v[140:143]
    ds_read_b64_tr_b16 a[8:9], v54 offset:16384
    v_mfma_f32_16x16x32_bf16 v[144:147], a[36:39], a[80:83], v[144:147]
    ds_read_b64_tr_b16 a[10:11], v54 offset:17408
    v_mfma_f32_16x16x32_bf16 v[148:151], a[36:39], a[84:87], v[148:151]
    ds_read_b64_tr_b16 a[12:13], v55 offset:16384
    v_mfma_f32_16x16x32_bf16 v[152:155], a[36:39], a[88:91], v[152:155]
    ds_read_b64_tr_b16 a[14:15], v55 offset:17408
    v_mfma_f32_16x16x32_bf16 v[156:159], a[36:39], a[92:95], v[156:159]
    ds_read_b64_tr_b16 a[16:17], v56 offset:16384
    v_mfma_f32_16x16x32_bf16 v[160:163], a[40:43], a[80:83], v[160:163]
    ds_read_b64_tr_b16 a[18:19], v56 offset:17408
    v_mfma_f32_16x16x32_bf16 v[164:167], a[40:43], a[84:87], v[164:167]
    ds_read_b64_tr_b16 a[20:21], v57 offset:16384
    v_mfma_f32_16x16x32_bf16 v[168:171], a[40:43], a[88:91], v[168:171]
    ds_read_b64_tr_b16 a[22:23], v57 offset:17408
    v_mfma_f32_16x16x32_bf16 v[172:175], a[40:43], a[92:95], v[172:175]
    ds_read_b64_tr_b16 a[24:25], v58 offset:16384
    ds_read_b64_tr_b16 a[26:27], v58 offset:17408
    v_mfma_f32_16x16x32_bf16 v[176:179], a[44:47], a[80:83], v[176:179]
    ds_read_b64_tr_b16 a[28:29], v59 offset:16384
    v_mfma_f32_16x16x32_bf16 v[180:183], a[44:47], a[84:87], v[180:183]
    ds_read_b64_tr_b16 a[30:31], v59 offset:17408
    v_mfma_f32_16x16x32_bf16 v[184:187], a[44:47], a[88:91], v[184:187]
    ds_read_b128 a[96:99], v16 offset:24576
    v_mfma_f32_16x16x32_bf16 v[188:191], a[44:47], a[92:95], v[188:191]
    ds_read_b128 a[100:103], v16 offset:26624
    buffer_load_dwordx4 v11, s[28:31], s51 offen offset:1024 lds
    s_lshr_b64 s[84:85], s[84:85], 4
    s_and_b32 s51, s84, 15
    s_lshl_b32 s51, s51, 19
    v_mfma_f32_16x16x32_bf16 v[192:195], a[48:51], a[80:83], v[192:195]
    ds_read_b128 a[104:107], v16 offset:28672
    v_mfma_f32_16x16x32_bf16 v[196:199], a[48:51], a[84:87], v[196:199]
    ds_read_b128 a[108:111], v16 offset:30720
    v_mfma_f32_16x16x32_bf16 v[200:203], a[48:51], a[88:91], v[200:203]
    ds_read_b128 a[112:115], v17 offset:24576
    v_mfma_f32_16x16x32_bf16 v[204:207], a[48:51], a[92:95], v[204:207]
    ds_read_b128 a[116:119], v17 offset:26624
    v_mfma_f32_16x16x32_bf16 v[208:211], a[52:55], a[80:83], v[208:211]
    ds_read_b128 a[120:123], v17 offset:28672
    v_mfma_f32_16x16x32_bf16 v[212:215], a[52:55], a[84:87], v[212:215]
    ds_read_b128 a[124:127], v17 offset:30720
    v_mfma_f32_16x16x32_bf16 v[216:219], a[52:55], a[88:91], v[216:219]
    v_mfma_f32_16x16x32_bf16 v[220:223], a[52:55], a[92:95], v[220:223]
    v_mfma_f32_16x16x32_bf16 v[224:227], a[56:59], a[80:83], v[224:227]
    v_mfma_f32_16x16x32_bf16 v[228:231], a[56:59], a[84:87], v[228:231]
    v_mfma_f32_16x16x32_bf16 v[232:235], a[56:59], a[88:91], v[232:235]
    v_mfma_f32_16x16x32_bf16 v[236:239], a[56:59], a[92:95], v[236:239]
    v_mfma_f32_16x16x32_bf16 v[240:243], a[60:63], a[80:83], v[240:243]
    v_mfma_f32_16x16x32_bf16 v[244:247], a[60:63], a[84:87], v[244:247]
    v_mfma_f32_16x16x32_bf16 v[248:251], a[60:63], a[88:91], v[248:251]
    v_mfma_f32_16x16x32_bf16 v[252:255], a[60:63], a[92:95], v[252:255]
    s_cmp_eq_u32 s54, 0
    s_cbranch_scc1 L1_kvskip
    s_cmp_eq_u32 s54, 1
    s_cbranch_scc0 L1_kvV
    s_lshl_b32 s55, s63, 13
    s_add_u32 s56, s55, 4096
    s_add_u32 m0, s48, 0
    s_nop 0
    buffer_load_dwordx4 v32, s[32:35], s55 offen offset:0 nt lds
    buffer_load_dwordx4 v33, s[32:35], s55 offen offset:1024 nt lds
    buffer_load_dwordx4 v34, s[32:35], s55 offen offset:2048 nt lds
    buffer_load_dwordx4 v35, s[32:35], s55 offen offset:3072 nt lds
    s_add_u32 m0, s48, 4096
    s_nop 0
    buffer_load_dwordx4 v32, s[32:35], s56 offen offset:0 nt lds
    buffer_load_dwordx4 v33, s[32:35], s56 offen offset:1024 nt lds
    buffer_load_dwordx4 v34, s[32:35], s56 offen offset:2048 nt lds
    buffer_load_dwordx4 v35, s[32:35], s56 offen offset:3072 nt lds
    s_branch L1_kvskip
L1_kvV:
    s_add_u32 m0, s48, 8192
    s_nop 0
    buffer_load_dwordx4 v36, s[36:39], s55 offen offset:0 nt lds
    buffer_load_dwordx4 v36, s[36:39], s55 offen offset:1024 nt lds
    buffer_load_dwordx4 v36, s[36:39], s55 offen offset:2048 nt lds
    buffer_load_dwordx4 v36, s[36:39], s55 offen offset:3072 nt lds
    s_add_u32 m0, s48, 12288
    s_nop 0
    buffer_load_dwordx4 v36, s[36:39], s56 offen offset:0 nt lds
    buffer_load_dwordx4 v36, s[36:39], s56 offen offset:1024 nt lds
    buffer_load_dwordx4 v36, s[36:39], s56 offen offset:2048 nt lds
    buffer_load_dwordx4 v36, s[36:39], s56 offen offset:3072 nt lds
    s_add_u32 s63, s63, 1
    s_and_b32 s63, s63, 15
    s_lshl_b32 s55, s63, 13
    s_add_u32 s56, s55, 4096
L1_kvskip:
    s_waitcnt vmcnt(12) lgkmcnt(0)
    s_barrier
    v_mfma_f32_16x16x32_bf16 v[128:131], a[0:3], a[96:99], v[128:131]
    s_add_u32 m0, s48, 24576
    ds_read_b64_tr_b16 a[32:33], v52 offset:24576
    buffer_load_dwordx4 v2, s[24:27], s50 offen offset:0 lds
    v_mfma_f32_16x16x32_bf16 v[132:135], a[0:3], a[100:103], v[132:135]
    ds_read_b64_tr_b16 a[34:35], v52 offset:25600
    v_mfma_f32_16x16x32_bf16 v[136:139], a[0:3], a[104:107], v[136:139]
    ds_read_b64_tr_b16 a[36:37], v53 offset:24576
    v_mfma_f32_16x16x32_bf16 v[140:143], a[0:3], a[108:111], v[140:143]
    buffer_load_dwordx4 v3, s[24:27], s50 offen offset:1024 lds
    v_mfma_f32_16x16x32_bf16 v[144:147], a[4:7], a[96:99], v[144:147]
    ds_read_b64_tr_b16 a[38:39], v53 offset:25600
    v_mfma_f32_16x16x32_bf16 v[148:151], a[4:7], a[100:103], v[148:151]
    ds_read_b64_tr_b16 a[40:41], v54 offset:24576
    v_mfma_f32_16x16x32_bf16 v[152:155], a[4:7], a[104:107], v[152:155]
    s_add_u32 m0, s49, 16384
    ds_read_b64_tr_b16 a[42:43], v54 offset:25600
    buffer_load_dwordx4 v10, s[28:31], s51 offen offset:0 lds
    v_mfma_f32_16x16x32_bf16 v[156:159], a[4:7], a[108:111], v[156:159]
    v_mfma_f32_16x16x32_bf16 v[160:163], a[8:11], a[96:99], v[160:163]
    ds_read_b64_tr_b16 a[44:45], v55 offset:24576
    v_mfma_f32_16x16x32_bf16 v[164:167], a[8:11], a[100:103], v[164:167]
    s_add_u32 m0, s48, 24576
    ds_read_b64_tr_b16 a[46:47], v55 offset:25600
    buffer_load_dwordx4 v4, s[24:27], s50 offen offset:2048 lds
    v_mfma_f32_16x16x32_bf16 v[168:171], a[8:11], a[104:107], v[168:171]
    v_mfma_f32_16x16x32_bf16 v[172:175], a[8:11], a[108:111], v[172:175]
    ds_read_b64_tr_b16 a[48:49], v56 offset:24576
    v_mfma_f32_16x16x32_bf16 v[176:179], a[12:15], a[96:99], v[176:179]
    ds_read_b64_tr_b16 a[50:51], v56 offset:25600
    buffer_load_dwordx4 v5, s[24:27], s50 offen offset:3072 lds
    v_mfma_f32_16x16x32_bf16 v[180:183], a[12:15], a[100:103], v[180:183]
    ds_read_b64_tr_b16 a[52:53], v57 offset:24576
    v_mfma_f32_16x16x32_bf16 v[184:187], a[12:15], a[104:107], v[184:187]
    v_mfma_f32_16x16x32_bf16 v[188:191], a[12:15], a[108:111], v[188:191]
    s_add_u32 m0, s49, 16384
    ds_read_b64_tr_b16 a[54:55], v57 offset:25600
    buffer_load_dwordx4 v11, s[28:31], s51 offen offset:1024 lds
    s_add_u32 s51, s51, 262144
    v_mfma_f32_16x16x32_bf16 v[192:195], a[16:19], a[96:99], v[192:195]
    ds_read_b64_tr_b16 a[56:57], v58 offset:24576
    v_mfma_f32_16x16x32_bf16 v[196:199], a[16:19], a[100:103], v[196:199]
    ds_read_b64_tr_b16 a[58:59], v58 offset:25600
    s_add_u32 m0, s48, 28672
    v_mfma_f32_16x16x32_bf16 v[200:203], a[16:19], a[104:107], v[200:203]
    buffer_load_dwordx4 v6, s[24:27], s50 offen offset:0 lds
    v_mfma_f32_16x16x32_bf16 v[204:207], a[16:19], a[108:111], v[204:207]
    ds_read_b64_tr_b16 a[60:61], v59 offset:24576
    v_mfma_f32_16x16x32_bf16 v[208:211], a[20:23], a[96:99], v[208:211]
    ds_read_b64_tr_b16 a[62:63], v59 offset:25600
    v_mfma_f32_16x16x32_bf16 v[212:215], a[20:23], a[100:103], v[212:215]
    buffer_load_dwordx4 v7, s[24:27], s50 offen offset:1024 lds
    v_mfma_f32_16x16x32_bf16 v[216:219], a[20:23], a[104:107], v[216:219]
    v_mfma_f32_16x16x32_bf16 v[220:223], a[20:23], a[108:111], v[220:223]
    v_mfma_f32_16x16x32_bf16 v[224:227], a[24:27], a[96:99], v[224:227]
    buffer_load_dwordx4 v8, s[24:27], s50 offen offset:2048 lds
    v_mfma_f32_16x16x32_bf16 v[228:231], a[24:27], a[100:103], v[228:231]
    v_mfma_f32_16x16x32_bf16 v[232:235], a[24:27], a[104:107], v[232:235]
    v_mfma_f32_16x16x32_bf16 v[236:239], a[24:27], a[108:111], v[236:239]
    buffer_load_dwordx4 v9, s[24:27], s50 offen offset:3072 lds
    s_lshr_b64 s[82:83], s[82:83], 4
    s_and_b32 s50, s82, 15
    s_lshl_b32 s50, s50, 7
    v_mfma_f32_16x16x32_bf16 v[240:243], a[28:31], a[96:99], v[240:243]
    v_mfma_f32_16x16x32_bf16 v[244:247], a[28:31], a[100:103], v[244:247]
    v_mfma_f32_16x16x32_bf16 v[248:251], a[28:31], a[104:107], v[248:251]
    v_mfma_f32_16x16x32_bf16 v[252:255], a[28:31], a[108:111], v[252:255]
    s_waitcnt vmcnt(12) lgkmcnt(0)
    s_barrier
    v_mfma_f32_16x16x32_bf16 v[128:131], a[32:35], a[112:115], v[128:131]
    ds_read_b64_tr_b16 a[0:1], v52 offset:0
    s_add_u32 m0, s49, 24576
    ds_read_b64_tr_b16 a[2:3], v52 offset:1024
    buffer_load_dwordx4 v10, s[28:31], s51 offen offset:0 lds
    v_mfma_f32_16x16x32_bf16 v[132:135], a[32:35], a[116:119], v[132:135]
    ds_read_b64_tr_b16 a[4:5], v53 offset:0
    v_mfma_f32_16x16x32_bf16 v[136:139], a[32:35], a[120:123], v[136:139]
    ds_read_b64_tr_b16 a[6:7], v53 offset:1024
    v_mfma_f32_16x16x32_bf16 v[140:143], a[32:35], a[124:127], v[140:143]
    ds_read_b64_tr_b16 a[8:9], v54 offset:0
    v_mfma_f32_16x16x32_bf16 v[144:147], a[36:39], a[112:115], v[144:147]
    ds_read_b64_tr_b16 a[10:11], v54 offset:1024
    v_mfma_f32_16x16x32_bf16 v[148:151], a[36:39], a[116:119], v[148:151]
    ds_read_b64_tr_b16 a[12:13], v55 offset:0
    v_mfma_f32_16x16x32_bf16 v[152:155], a[36:39], a[120:123], v[152:155]
    ds_read_b64_tr_b16 a[14:15], v55 offset:1024
    v_mfma_f32_16x16x32_bf16 v[156:159], a[36:39], a[124:127], v[156:159]
    ds_read_b64_tr_b16 a[16:17], v56 offset:0
    v_mfma_f32_16x16x32_bf16 v[160:163], a[40:43], a[112:115], v[160:163]
    ds_read_b64_tr_b16 a[18:19], v56 offset:1024
    v_mfma_f32_16x16x32_bf16 v[164:167], a[40:43], a[116:119], v[164:167]
    ds_read_b64_tr_b16 a[20:21], v57 offset:0
    v_mfma_f32_16x16x32_bf16 v[168:171], a[40:43], a[120:123], v[168:171]
    ds_read_b64_tr_b16 a[22:23], v57 offset:1024
    v_mfma_f32_16x16x32_bf16 v[172:175], a[40:43], a[124:127], v[172:175]
    ds_read_b64_tr_b16 a[24:25], v58 offset:0
    ds_read_b64_tr_b16 a[26:27], v58 offset:1024
    v_mfma_f32_16x16x32_bf16 v[176:179], a[44:47], a[112:115], v[176:179]
    ds_read_b64_tr_b16 a[28:29], v59 offset:0
    v_mfma_f32_16x16x32_bf16 v[180:183], a[44:47], a[116:119], v[180:183]
    ds_read_b64_tr_b16 a[30:31], v59 offset:1024
    v_mfma_f32_16x16x32_bf16 v[184:187], a[44:47], a[120:123], v[184:187]
    ds_read_b128 a[64:67], v16 offset:16384
    v_mfma_f32_16x16x32_bf16 v[188:191], a[44:47], a[124:127], v[188:191]
    ds_read_b128 a[68:71], v16 offset:18432
    buffer_load_dwordx4 v11, s[28:31], s51 offen offset:1024 lds
    s_lshr_b64 s[84:85], s[84:85], 4
    s_and_b32 s51, s84, 15
    s_lshl_b32 s51, s51, 19
    v_mfma_f32_16x16x32_bf16 v[192:195], a[48:51], a[112:115], v[192:195]
    ds_read_b128 a[72:75], v16 offset:20480
    v_mfma_f32_16x16x32_bf16 v[196:199], a[48:51], a[116:119], v[196:199]
    ds_read_b128 a[76:79], v16 offset:22528
    v_mfma_f32_16x16x32_bf16 v[200:203], a[48:51], a[120:123], v[200:203]
    ds_read_b128 a[80:83], v17 offset:16384
    v_mfma_f32_16x16x32_bf16 v[204:207], a[48:51], a[124:127], v[204:207]
    ds_read_b128 a[84:87], v17 offset:18432
    v_mfma_f32_16x16x32_bf16 v[208:211], a[52:55], a[112:115], v[208:211]
    ds_read_b128 a[88:91], v17 offset:20480
    v_mfma_f32_16x16x32_bf16 v[212:215], a[52:55], a[116:119], v[212:215]
    ds_read_b128 a[92:95], v17 offset:22528
    v_mfma_f32_16x16x32_bf16 v[216:219], a[52:55], a[120:123], v[216:219]
    v_mfma_f32_16x16x32_bf16 v[220:223], a[52:55], a[124:127], v[220:223]
    v_mfma_f32_16x16x32_bf16 v[224:227], a[56:59], a[112:115], v[224:227]
    v_mfma_f32_16x16x32_bf16 v[228:231], a[56:59], a[116:119], v[228:231]
    v_mfma_f32_16x16x32_bf16 v[232:235], a[56:59], a[120:123], v[232:235]
    v_mfma_f32_16x16x32_bf16 v[236:239], a[56:59], a[124:127], v[236:239]
    v_mfma_f32_16x16x32_bf16 v[240:243], a[60:63], a[112:115], v[240:243]
    v_mfma_f32_16x16x32_bf16 v[244:247], a[60:63], a[116:119], v[244:247]
    v_mfma_f32_16x16x32_bf16 v[248:251], a[60:63], a[120:123], v[248:251]
    v_mfma_f32_16x16x32_bf16 v[252:255], a[60:63], a[124:127], v[252:255]
    s_add_u32 s54, s54, 1
    s_cmp_lt_u32 s54, 3
    s_cbranch_scc1 L1_p1loop
    s_waitcnt vmcnt(12) lgkmcnt(0)
    s_barrier
    v_mfma_f32_16x16x32_bf16 v[128:131], a[0:3], a[64:67], v[128:131]
    s_add_u32 m0, s48, 16384
    ds_read_b64_tr_b16 a[32:33], v52 offset:8192
    buffer_load_dwordx4 v32, s[32:35], s55 offen offset:0 nt lds
    v_mfma_f32_16x16x32_bf16 v[132:135], a[0:3], a[68:71], v[132:135]
    ds_read_b64_tr_b16 a[34:35], v52 offset:9216
    v_mfma_f32_16x16x32_bf16 v[136:139], a[0:3], a[72:75], v[136:139]
    ds_read_b64_tr_b16 a[36:37], v53 offset:8192
    v_mfma_f32_16x16x32_bf16 v[140:143], a[0:3], a[76:79], v[140:143]
    buffer_load_dwordx4 v33, s[32:35], s55 offen offset:1024 nt lds
    v_mfma_f32_16x16x32_bf16 v[144:147], a[4:7], a[64:67], v[144:147]
    ds_read_b64_tr_b16 a[38:39], v53 offset:9216
    v_mfma_f32_16x16x32_bf16 v[148:151], a[4:7], a[68:71], v[148:151]
    ds_read_b64_tr_b16 a[40:41], v54 offset:8192
    v_mfma_f32_16x16x32_bf16 v[152:155], a[4:7], a[72:75], v[152:155]
    ds_read_b64_tr_b16 a[42:43], v54 offset:9216
    v_mfma_f32_16x16x32_bf16 v[156:159], a[4:7], a[76:79], v[156:159]
    buffer_load_dwordx4 v34, s[32:35], s55 offen offset:2048 nt lds
    v_mfma_f32_16x16x32_bf16 v[160:163], a[8:11], a[64:67], v[160:163]
    ds_read_b64_tr_b16 a[44:45], v55 offset:8192
    v_mfma_f32_16x16x32_bf16 v[164:167], a[8:11], a[68:71], v[164:167]
    ds_read_b64_tr_b16 a[46:47], v55 offset:9216
    v_mfma_f32_16x16x32_bf16 v[168:171], a[8:11], a[72:75], v[168:171]
    v_mfma_f32_16x16x32_bf16 v[172:175], a[8:11], a[76:79], v[172:175]
    ds_read_b64_tr_b16 a[48:49], v56 offset:8192
    buffer_load_dwordx4 v35, s[32:35], s55 offen offset:3072 nt lds
    v_mfma_f32_16x16x32_bf16 v[176:179], a[12:15], a[64:67], v[176:179]
    ds_read_b64_tr_b16 a[50:51], v56 offset:9216
    v_mfma_f32_16x16x32_bf16 v[180:183], a[12:15], a[68:71], v[180:183]
    ds_read_b64_tr_b16 a[52:53], v57 offset:8192
    v_mfma_f32_16x16x32_bf16 v[184:187], a[12:15], a[72:75], v[184:187]
    v_mfma_f32_16x16x32_bf16 v[188:191], a[12:15], a[76:79], v[188:191]
    s_add_u32 m0, s48, 20480
    ds_read_b64_tr_b16 a[54:55], v57 offset:9216
    buffer_load_dwordx4 v32, s[32:35], s56 offen offset:0 nt lds
    v_mfma_f32_16x16x32_bf16 v[192:195], a[16:19], a[64:67], v[192:195]
    ds_read_b64_tr_b16 a[56:57], v58 offset:8192
    v_mfma_f32_16x16x32_bf16 v[196:199], a[16:19], a[68:71], v[196:199]
    ds_read_b64_tr_b16 a[58:59], v58 offset:9216
    v_mfma_f32_16x16x32_bf16 v[200:203], a[16:19], a[72:75], v[200:203]
    v_mfma_f32_16x16x32_bf16 v[204:207], a[16:19], a[76:79], v[204:207]
    ds_read_b64_tr_b16 a[60:61], v59 offset:8192
    buffer_load_dwordx4 v33, s[32:35], s56 offen offset:1024 nt lds
    v_mfma_f32_16x16x32_bf16 v[208:211], a[20:23], a[64:67], v[208:211]
    ds_read_b64_tr_b16 a[62:63], v59 offset:9216
    v_mfma_f32_16x16x32_bf16 v[212:215], a[20:23], a[68:71], v[212:215]
    v_mfma_f32_16x16x32_bf16 v[216:219], a[20:23], a[72:75], v[216:219]
    v_mfma_f32_16x16x32_bf16 v[220:223], a[20:23], a[76:79], v[220:223]
    buffer_load_dwordx4 v34, s[32:35], s56 offen offset:2048 nt lds
    v_mfma_f32_16x16x32_bf16 v[224:227], a[24:27], a[64:67], v[224:227]
    v_mfma_f32_16x16x32_bf16 v[228:231], a[24:27], a[68:71], v[228:231]
    v_mfma_f32_16x16x32_bf16 v[232:235], a[24:27], a[72:75], v[232:235]
    v_mfma_f32_16x16x32_bf16 v[236:239], a[24:27], a[76:79], v[236:239]
    buffer_load_dwordx4 v35, s[32:35], s56 offen offset:3072 nt lds
    v_mfma_f32_16x16x32_bf16 v[240:243], a[28:31], a[64:67], v[240:243]
    v_mfma_f32_16x16x32_bf16 v[244:247], a[28:31], a[68:71], v[244:247]
    v_mfma_f32_16x16x32_bf16 v[248:251], a[28:31], a[72:75], v[248:251]
    v_mfma_f32_16x16x32_bf16 v[252:255], a[28:31], a[76:79], v[252:255]
    s_waitcnt vmcnt(10) lgkmcnt(0)
    s_barrier
    v_mfma_f32_16x16x32_bf16 v[128:131], a[32:35], a[80:83], v[128:131]
    ds_read_b64_tr_b16 a[0:1], v52 offset:16384
    ds_read_b64_tr_b16 a[2:3], v52 offset:17408
    v_mfma_f32_16x16x32_bf16 v[132:135], a[32:35], a[84:87], v[132:135]
    ds_read_b64_tr_b16 a[4:5], v53 offset:16384
    v_mfma_f32_16x16x32_bf16 v[136:139], a[32:35], a[88:91], v[136:139]
    ds_read_b64_tr_b16 a[6:7], v53 offset:17408
    v_mfma_f32_16x16x32_bf16 v[140:143], a[32:35], a[92:95], v[140:143]
    ds_read_b64_tr_b16 a[8:9], v54 offset:16384
    v_mfma_f32_16x16x32_bf16 v[144:147], a[36:39], a[80:83], v[144:147]
    ds_read_b64_tr_b16 a[10:11], v54 offset:17408
    v_mfma_f32_16x16x32_bf16 v[148:151], a[36:39], a[84:87], v[148:151]
    ds_read_b64_tr_b16 a[12:13], v55 offset:16384
    v_mfma_f32_16x16x32_bf16 v[152:155], a[36:39], a[88:91], v[152:155]
    ds_read_b64_tr_b16 a[14:15], v55 offset:17408
    v_mfma_f32_16x16x32_bf16 v[156:159], a[36:39], a[92:95], v[156:159]
    ds_read_b64_tr_b16 a[16:17], v56 offset:16384
    v_mfma_f32_16x16x32_bf16 v[160:163], a[40:43], a[80:83], v[160:163]
    ds_read_b64_tr_b16 a[18:19], v56 offset:17408
    v_mfma_f32_16x16x32_bf16 v[164:167], a[40:43], a[84:87], v[164:167]
    ds_read_b64_tr_b16 a[20:21], v57 offset:16384
    v_mfma_f32_16x16x32_bf16 v[168:171], a[40:43], a[88:91], v[168:171]
    ds_read_b64_tr_b16 a[22:23], v57 offset:17408
    v_mfma_f32_16x16x32_bf16 v[172:175], a[40:43], a[92:95], v[172:175]
    ds_read_b64_tr_b16 a[24:25], v58 offset:16384
    ds_read_b64_tr_b16 a[26:27], v58 offset:17408
    v_mfma_f32_16x16x32_bf16 v[176:179], a[44:47], a[80:83], v[176:179]
    ds_read_b64_tr_b16 a[28:29], v59 offset:16384
    v_mfma_f32_16x16x32_bf16 v[180:183], a[44:47], a[84:87], v[180:183]
    ds_read_b64_tr_b16 a[30:31], v59 offset:17408
    v_mfma_f32_16x16x32_bf16 v[184:187], a[44:47], a[88:91], v[184:187]
    ds_read_b128 a[96:99], v16 offset:24576
    v_mfma_f32_16x16x32_bf16 v[188:191], a[44:47], a[92:95], v[188:191]
    ds_read_b128 a[100:103], v16 offset:26624
    v_mfma_f32_16x16x32_bf16 v[192:195], a[48:51], a[80:83], v[192:195]
    ds_read_b128 a[104:107], v16 offset:28672
    v_mfma_f32_16x16x32_bf16 v[196:199], a[48:51], a[84:87], v[196:199]
    ds_read_b128 a[108:111], v16 offset:30720
    v_mfma_f32_16x16x32_bf16 v[200:203], a[48:51], a[88:91], v[200:203]
    ds_read_b128 a[112:115], v17 offset:24576
    v_mfma_f32_16x16x32_bf16 v[204:207], a[48:51], a[92:95], v[204:207]
    ds_read_b128 a[116:119], v17 offset:26624
    v_mfma_f32_16x16x32_bf16 v[208:211], a[52:55], a[80:83], v[208:211]
    ds_read_b128 a[120:123], v17 offset:28672
    v_mfma_f32_16x16x32_bf16 v[212:215], a[52:55], a[84:87], v[212:215]
    ds_read_b128 a[124:127], v17 offset:30720
    v_mfma_f32_16x16x32_bf16 v[216:219], a[52:55], a[88:91], v[216:219]
    v_mfma_f32_16x16x32_bf16 v[220:223], a[52:55], a[92:95], v[220:223]
    v_mfma_f32_16x16x32_bf16 v[224:227], a[56:59], a[80:83], v[224:227]
    v_mfma_f32_16x16x32_bf16 v[228:231], a[56:59], a[84:87], v[228:231]
    v_mfma_f32_16x16x32_bf16 v[232:235], a[56:59], a[88:91], v[232:235]
    v_mfma_f32_16x16x32_bf16 v[236:239], a[56:59], a[92:95], v[236:239]
    v_mfma_f32_16x16x32_bf16 v[240:243], a[60:63], a[80:83], v[240:243]
    v_mfma_f32_16x16x32_bf16 v[244:247], a[60:63], a[84:87], v[244:247]
    v_mfma_f32_16x16x32_bf16 v[248:251], a[60:63], a[88:91], v[248:251]
    v_mfma_f32_16x16x32_bf16 v[252:255], a[60:63], a[92:95], v[252:255]
    s_waitcnt vmcnt(8) lgkmcnt(0)
    s_barrier
    v_mfma_f32_16x16x32_bf16 v[128:131], a[0:3], a[96:99], v[128:131]
    s_add_u32 m0, s48, 24576
    ds_read_b64_tr_b16 a[32:33], v52 offset:24576
    buffer_load_dwordx4 v36, s[36:39], s55 offen offset:0 nt lds
    v_mfma_f32_16x16x32_bf16 v[132:135], a[0:3], a[100:103], v[132:135]
    ds_read_b64_tr_b16 a[34:35], v52 offset:25600
    v_mfma_f32_16x16x32_bf16 v[136:139], a[0:3], a[104:107], v[136:139]
    ds_read_b64_tr_b16 a[36:37], v53 offset:24576
    v_mfma_f32_16x16x32_bf16 v[140:143], a[0:3], a[108:111], v[140:143]
    buffer_load_dwordx4 v36, s[36:39], s55 offen offset:1024 nt lds
    v_mfma_f32_16x16x32_bf16 v[144:147], a[4:7], a[96:99], v[144:147]
    ds_read_b64_tr_b16 a[38:39], v53 offset:25600
    v_mfma_f32_16x16x32_bf16 v[148:151], a[4:7], a[100:103], v[148:151]
    ds_read_b64_tr_b16 a[40:41], v54 offset:24576
    v_mfma_f32_16x16x32_bf16 v[152:155], a[4:7], a[104:107], v[152:155]
    ds_read_b64_tr_b16 a[42:43], v54 offset:25600
    v_mfma_f32_16x16x32_bf16 v[156:159], a[4:7], a[108:111], v[156:159]
    buffer_load_dwordx4 v36, s[36:39], s55 offen offset:2048 nt lds
    v_mfma_f32_16x16x32_bf16 v[160:163], a[8:11], a[96:99], v[160:163]
    ds_read_b64_tr_b16 a[44:45], v55 offset:24576
    v_mfma_f32_16x16x32_bf16 v[164:167], a[8:11], a[100:103], v[164:167]
    ds_read_b64_tr_b16 a[46:47], v55 offset:25600
    v_mfma_f32_16x16x32_bf16 v[168:171], a[8:11], a[104:107], v[168:171]
    v_mfma_f32_16x16x32_bf16 v[172:175], a[8:11], a[108:111], v[172:175]
    ds_read_b64_tr_b16 a[48:49], v56 offset:24576
    buffer_load_dwordx4 v36, s[36:39], s55 offen offset:3072 nt lds
    v_mfma_f32_16x16x32_bf16 v[176:179], a[12:15], a[96:99], v[176:179]
    ds_read_b64_tr_b16 a[50:51], v56 offset:25600
    v_mfma_f32_16x16x32_bf16 v[180:183], a[12:15], a[100:103], v[180:183]
    ds_read_b64_tr_b16 a[52:53], v57 offset:24576
    v_mfma_f32_16x16x32_bf16 v[184:187], a[12:15], a[104:107], v[184:187]
    v_mfma_f32_16x16x32_bf16 v[188:191], a[12:15], a[108:111], v[188:191]
    s_add_u32 m0, s48, 28672
    ds_read_b64_tr_b16 a[54:55], v57 offset:25600
    buffer_load_dwordx4 v36, s[36:39], s56 offen offset:0 nt lds
    v_mfma_f32_16x16x32_bf16 v[192:195], a[16:19], a[96:99], v[192:195]
    ds_read_b64_tr_b16 a[56:57], v58 offset:24576
    v_mfma_f32_16x16x32_bf16 v[196:199], a[16:19], a[100:103], v[196:199]
    ds_read_b64_tr_b16 a[58:59], v58 offset:25600
    v_mfma_f32_16x16x32_bf16 v[200:203], a[16:19], a[104:107], v[200:203]
    v_mfma_f32_16x16x32_bf16 v[204:207], a[16:19], a[108:111], v[204:207]
    ds_read_b64_tr_b16 a[60:61], v59 offset:24576
    buffer_load_dwordx4 v36, s[36:39], s56 offen offset:1024 nt lds
    v_mfma_f32_16x16x32_bf16 v[208:211], a[20:23], a[96:99], v[208:211]
    ds_read_b64_tr_b16 a[62:63], v59 offset:25600
    v_mfma_f32_16x16x32_bf16 v[212:215], a[20:23], a[100:103], v[212:215]
    v_mfma_f32_16x16x32_bf16 v[216:219], a[20:23], a[104:107], v[216:219]
    v_mfma_f32_16x16x32_bf16 v[220:223], a[20:23], a[108:111], v[220:223]
    buffer_load_dwordx4 v36, s[36:39], s56 offen offset:2048 nt lds
    v_mfma_f32_16x16x32_bf16 v[224:227], a[24:27], a[96:99], v[224:227]
    v_mfma_f32_16x16x32_bf16 v[228:231], a[24:27], a[100:103], v[228:231]
    v_mfma_f32_16x16x32_bf16 v[232:235], a[24:27], a[104:107], v[232:235]
    v_mfma_f32_16x16x32_bf16 v[236:239], a[24:27], a[108:111], v[236:239]
    buffer_load_dwordx4 v36, s[36:39], s56 offen offset:3072 nt lds
    v_mfma_f32_16x16x32_bf16 v[240:243], a[28:31], a[96:99], v[240:243]
    v_mfma_f32_16x16x32_bf16 v[244:247], a[28:31], a[100:103], v[244:247]
    v_mfma_f32_16x16x32_bf16 v[248:251], a[28:31], a[104:107], v[248:251]
    v_mfma_f32_16x16x32_bf16 v[252:255], a[28:31], a[108:111], v[252:255]
    s_waitcnt lgkmcnt(0)
    v_mfma_f32_16x16x32_bf16 v[128:131], a[32:35], a[112:115], v[128:131]
    v_mfma_f32_16x16x32_bf16 v[132:135], a[32:35], a[116:119], v[132:135]
    v_mfma_f32_16x16x32_bf16 v[136:139], a[32:35], a[120:123], v[136:139]
    v_mfma_f32_16x16x32_bf16 v[140:143], a[32:35], a[124:127], v[140:143]
    v_mfma_f32_16x16x32_bf16 v[144:147], a[36:39], a[112:115], v[144:147]
    v_mfma_f32_16x16x32_bf16 v[148:151], a[36:39], a[116:119], v[148:151]
    v_mfma_f32_16x16x32_bf16 v[152:155], a[36:39], a[120:123], v[152:155]
    v_mfma_f32_16x16x32_bf16 v[156:159], a[36:39], a[124:127], v[156:159]
    v_mfma_f32_16x16x32_bf16 v[160:163], a[40:43], a[112:115], v[160:163]
    v_mfma_f32_16x16x32_bf16 v[164:167], a[40:43], a[116:119], v[164:167]
    v_mfma_f32_16x16x32_bf16 v[168:171], a[40:43], a[120:123], v[168:171]
    v_mfma_f32_16x16x32_bf16 v[172:175], a[40:43], a[124:127], v[172:175]
    v_mfma_f32_16x16x32_bf16 v[176:179], a[44:47], a[112:115], v[176:179]
    v_mfma_f32_16x16x32_bf16 v[180:183], a[44:47], a[116:119], v[180:183]
    v_mfma_f32_16x16x32_bf16 v[184:187], a[44:47], a[120:123], v[184:187]
    v_mfma_f32_16x16x32_bf16 v[188:191], a[44:47], a[124:127], v[188:191]
    v_mfma_f32_16x16x32_bf16 v[192:195], a[48:51], a[112:115], v[192:195]
    v_mfma_f32_16x16x32_bf16 v[196:199], a[48:51], a[116:119], v[196:199]
    v_mfma_f32_16x16x32_bf16 v[200:203], a[48:51], a[120:123], v[200:203]
    v_mfma_f32_16x16x32_bf16 v[204:207], a[48:51], a[124:127], v[204:207]
    v_mfma_f32_16x16x32_bf16 v[208:211], a[52:55], a[112:115], v[208:211]
    v_mfma_f32_16x16x32_bf16 v[212:215], a[52:55], a[116:119], v[212:215]
    v_mfma_f32_16x16x32_bf16 v[216:219], a[52:55], a[120:123], v[216:219]
    v_mfma_f32_16x16x32_bf16 v[220:223], a[52:55], a[124:127], v[220:223]
    v_mfma_f32_16x16x32_bf16 v[224:227], a[56:59], a[112:115], v[224:227]
    v_mfma_f32_16x16x32_bf16 v[228:231], a[56:59], a[116:119], v[228:231]
    v_mfma_f32_16x16x32_bf16 v[232:235], a[56:59], a[120:123], v[232:235]
    v_mfma_f32_16x16x32_bf16 v[236:239], a[56:59], a[124:127], v[236:239]
    v_mfma_f32_16x16x32_bf16 v[240:243], a[60:63], a[112:115], v[240:243]
    v_mfma_f32_16x16x32_bf16 v[244:247], a[60:63], a[116:119], v[244:247]
    v_mfma_f32_16x16x32_bf16 v[248:251], a[60:63], a[120:123], v[248:251]
    v_mfma_f32_16x16x32_bf16 v[252:255], a[60:63], a[124:127], v[252:255]
    v_cvt_pk_bf16_f32 v64, v128, v129
    v_cvt_pk_bf16_f32 v65, v130, v131
    v_cvt_pk_bf16_f32 v66, v132, v133
    v_cvt_pk_bf16_f32 v67, v134, v135
    v_cvt_pk_bf16_f32 v68, v144, v145
    v_cvt_pk_bf16_f32 v69, v146, v147
    v_cvt_pk_bf16_f32 v70, v148, v149
    v_cvt_pk_bf16_f32 v71, v150, v151
    v_cvt_pk_bf16_f32 v72, v160, v161
    v_cvt_pk_bf16_f32 v73, v162, v163
    v_cvt_pk_bf16_f32 v74, v164, v165
    v_cvt_pk_bf16_f32 v75, v166, v167
    v_cvt_pk_bf16_f32 v76, v176, v177
    v_cvt_pk_bf16_f32 v77, v178, v179
    v_cvt_pk_bf16_f32 v78, v180, v181
    v_cvt_pk_bf16_f32 v79, v182, v183
    v_cvt_pk_bf16_f32 v80, v192, v193
    v_cvt_pk_bf16_f32 v81, v194, v195
    v_cvt_pk_bf16_f32 v82, v196, v197
    v_cvt_pk_bf16_f32 v83, v198, v199
    v_cvt_pk_bf16_f32 v84, v208, v209
    v_cvt_pk_bf16_f32 v85, v210, v211
    v_cvt_pk_bf16_f32 v86, v212, v213
    v_cvt_pk_bf16_f32 v87, v214, v215
    v_cvt_pk_bf16_f32 v88, v224, v225
    v_cvt_pk_bf16_f32 v89, v226, v227
    v_cvt_pk_bf16_f32 v90, v228, v229
    v_cvt_pk_bf16_f32 v91, v230, v231
    v_cvt_pk_bf16_f32 v92, v240, v241
    v_cvt_pk_bf16_f32 v93, v242, v243
    v_cvt_pk_bf16_f32 v94, v244, v245
    v_cvt_pk_bf16_f32 v95, v246, v247
    v_permlane16_swap_b32 v64, v66
    v_permlane16_swap_b32 v65, v67
    v_permlane16_swap_b32 v68, v70
    v_permlane16_swap_b32 v69, v71
    v_permlane16_swap_b32 v72, v74
    v_permlane16_swap_b32 v73, v75
    v_permlane16_swap_b32 v76, v78
    v_permlane16_swap_b32 v77, v79
    v_permlane16_swap_b32 v80, v82
    v_permlane16_swap_b32 v81, v83
    v_permlane16_swap_b32 v84, v86
    v_permlane16_swap_b32 v85, v87
    v_permlane16_swap_b32 v88, v90
    v_permlane16_swap_b32 v89, v91
    v_permlane16_swap_b32 v92, v94
    v_permlane16_swap_b32 v93, v95
    v_cvt_pk_bf16_f32 v96, v136, v137
    v_cvt_pk_bf16_f32 v97, v138, v139
    v_cvt_pk_bf16_f32 v98, v140, v141
    v_cvt_pk_bf16_f32 v99, v142, v143
    v_cvt_pk_bf16_f32 v100, v152, v153
    v_cvt_pk_bf16_f32 v101, v154, v155
    v_cvt_pk_bf16_f32 v102, v156, v157
    v_cvt_pk_bf16_f32 v103, v158, v159
    v_cvt_pk_bf16_f32 v104, v168, v169
    v_cvt_pk_bf16_f32 v105, v170, v171
    v_cvt_pk_bf16_f32 v106, v172, v173
    v_cvt_pk_bf16_f32 v107, v174, v175
    v_cvt_pk_bf16_f32 v108, v184, v185
    v_cvt_pk_bf16_f32 v109, v186, v187
    v_cvt_pk_bf16_f32 v110, v188, v189
    v_cvt_pk_bf16_f32 v111, v190, v191
    v_cvt_pk_bf16_f32 v112, v200, v201
    v_cvt_pk_bf16_f32 v113, v202, v203
    v_cvt_pk_bf16_f32 v114, v204, v205
    v_cvt_pk_bf16_f32 v115, v206, v207
    v_cvt_pk_bf16_f32 v116, v216, v217
    v_cvt_pk_bf16_f32 v117, v218, v219
    v_cvt_pk_bf16_f32 v118, v220, v221
    v_cvt_pk_bf16_f32 v119, v222, v223
    v_cvt_pk_bf16_f32 v120, v232, v233
    v_cvt_pk_bf16_f32 v121, v234, v235
    v_cvt_pk_bf16_f32 v122, v236, v237
    v_cvt_pk_bf16_f32 v123, v238, v239
    v_cvt_pk_bf16_f32 v124, v248, v249
    v_cvt_pk_bf16_f32 v125, v250, v251
    v_cvt_pk_bf16_f32 v126, v252, v253
    v_cvt_pk_bf16_f32 v127, v254, v255
    v_permlane16_swap_b32 v96, v98
    v_permlane16_swap_b32 v97, v99
    v_permlane16_swap_b32 v100, v102
    v_permlane16_swap_b32 v101, v103
    v_permlane16_swap_b32 v104, v106
    v_permlane16_swap_b32 v105, v107
    v_permlane16_swap_b32 v108, v110
    v_permlane16_swap_b32 v109, v111
    v_permlane16_swap_b32 v112, v114
    v_permlane16_swap_b32 v113, v115
    v_permlane16_swap_b32 v116, v118
    v_permlane16_swap_b32 v117, v119
    v_permlane16_swap_b32 v120, v122
    v_permlane16_swap_b32 v121, v123
    v_permlane16_swap_b32 v124, v126
    v_permlane16_swap_b32 v125, v127
    v_mov_b32 v50, 0xff800000
    v_mov_b32 v52, 0xff800000
    v_mov_b32 v54, 0
    v_mov_b32 v51, 0xff800000
    v_mov_b32 v53, 0xff800000
    v_mov_b32 v55, 0
    s_add_u32 s63, s63, 1
    s_and_b32 s63, s63, 15
    s_lshl_b32 s55, s63, 13
    s_add_u32 s56, s55, 4096
    s_mov_b32 s54, 0
L1_p2loop:
    s_waitcnt vmcnt(24)
    ds_read_b128 a[0:3], v38 offset:0
    ds_read_b128 a[4:7], v39 offset:0
    ds_read_b128 a[8:11], v40 offset:0
    ds_read_b128 a[12:15], v41 offset:0
    ds_read_b128 a[16:19], v42 offset:0
    ds_read_b128 a[20:23], v43 offset:0
    ds_read_b128 a[24:27], v44 offset:0
    ds_read_b128 a[28:31], v45 offset:0
    s_add_u32 s58, s54, 2
    s_cmp_lt_u32 s58, 16
    s_cselect_b32 s34, 131072, 0
    s_cselect_b32 s38, 131072, 0
    s_waitcnt lgkmcnt(0)
    v_mfma_f32_32x32x16_bf16 v[0:15], a[0:3], v[64:67], 0
    s_add_u32 m0, s48, 0
    s_waitcnt vmcnt(4)
    buffer_load_dwordx4 v32, s[32:35], s55 offen offset:0 nt lds
    v_mfma_f32_32x32x16_bf16 v[0:15], a[4:7], v[68:71], v[0:15]
    v_mfma_f32_32x32x16_bf16 v[0:15], a[8:11], v[72:75], v[0:15]
    s_waitcnt vmcnt(4)
    buffer_load_dwordx4 v33, s[32:35], s55 offen offset:1024 nt lds
    v_mfma_f32_32x32x16_bf16 v[0:15], a[12:15], v[76:79], v[0:15]
    v_mfma_f32_32x32x16_bf16 v[0:15], a[16:19], v[80:83], v[0:15]
    s_waitcnt vmcnt(4)
    buffer_load_dwordx4 v34, s[32:35], s55 offen offset:2048 nt lds
    v_mfma_f32_32x32x16_bf16 v[0:15], a[20:23], v[84:87], v[0:15]
    v_mfma_f32_32x32x16_bf16 v[0:15], a[24:27], v[88:91], v[0:15]
    s_waitcnt vmcnt(4)
    buffer_load_dwordx4 v35, s[32:35], s55 offen offset:3072 nt lds
    v_mfma_f32_32x32x16_bf16 v[0:15], a[28:31], v[92:95], v[0:15]
    s_waitcnt vmcnt(20)
    v_mfma_f32_32x32x16_bf16 v[16:31], a[0:3], v[96:99], 0
    ds_read_b64_tr_b16 a[32:33], v46 offset:8192
    ds_read_b64_tr_b16 a[34:35], v46 offset:10240
    ds_read_b64_tr_b16 a[36:37], v46 offset:12288
    ds_read_b64_tr_b16 a[38:39], v46 offset:14336
    v_mfma_f32_32x32x16_bf16 v[16:31], a[4:7], v[100:103], v[16:31]
    ds_read_b64_tr_b16 a[40:41], v47 offset:8192
    ds_read_b64_tr_b16 a[42:43], v47 offset:10240
    ds_read_b64_tr_b16 a[44:45], v47 offset:12288
    ds_read_b64_tr_b16 a[46:47], v47 offset:14336
    v_mfma_f32_32x32x16_bf16 v[16:31], a[8:11], v[104:107], v[16:31]
    ds_read_b64_tr_b16 a[48:49], v48 offset:8192
    ds_read_b64_tr_b16 a[50:51], v48 offset:10240
    ds_read_b64_tr_b16 a[52:53], v48 offset:12288
    ds_read_b64_tr_b16 a[54:55], v48 offset:14336
    s_add_u32 m0, s48, 4096
    s_waitcnt vmcnt(4)
    buffer_load_dwordx4 v32, s[32:35], s56 offen offset:0 nt lds
    v_mfma_f32_32x32x16_bf16 v[16:31], a[12:15], v[108:111], v[16:31]
    ds_read_b64_tr_b16 a[56:57], v49 offset:8192
    ds_read_b64_tr_b16 a[58:59], v49 offset:10240
    ds_read_b64_tr_b16 a[60:61], v49 offset:12288
    ds_read_b64_tr_b16 a[62:63], v49 offset:14336
    s_waitcnt vmcnt(4)
    buffer_load_dwordx4 v33, s[32:35], s56 offen offset:1024 nt lds
    v_mfma_f32_32x32x16_bf16 v[16:31], a[16:19], v[112:115], v[16:31]
    s_waitcnt vmcnt(4)
    buffer_load_dwordx4 v34, s[32:35], s56 offen offset:2048 nt lds
    v_max3_f32 v58, v0, v1, v2
    v_max3_f32 v58, v58, v3, v4
    v_mfma_f32_32x32x16_bf16 v[16:31], a[20:23], v[116:119], v[16:31]
    v_max3_f32 v58, v58, v5, v6
    v_max3_f32 v58, v58, v7, v8
    s_waitcnt vmcnt(4)
    buffer_load_dwordx4 v35, s[32:35], s56 offen offset:3072 nt lds
    v_mfma_f32_32x32x16_bf16 v[16:31], a[24:27], v[120:123], v[16:31]
    v_max3_f32 v58, v58, v9, v10
    v_max3_f32 v58, v58, v11, v12
    v_max3_f32 v58, v58, v13, v14
    v_max_f32 v58, v58, v15
    v_mfma_f32_32x32x16_bf16 v[16:31], a[28:31], v[124:127], v[16:31]
    v_mov_b32 v59, v58
    s_nop 1
    v_permlane32_swap_b32 v58, v59
    v_max_f32 v58, v58, v59
    v_sub_f32 v59, v58, v50
    v_cmp_lt_f32 vcc, s69, v59
    s_nop 1
    s_cbranch_vccnz L1_rs00
L1_rb00:
    v_fma_f32 v0, v0, s57, -v52
    v_fma_f32 v1, v1, s57, -v52
    v_fma_f32 v2, v2, s57, -v52
    v_fma_f32 v3, v3, s57, -v52
    v_fma_f32 v4, v4, s57, -v52
    v_fma_f32 v5, v5, s57, -v52
    v_fma_f32 v6, v6, s57, -v52
    v_fma_f32 v7, v7, s57, -v52
    v_fma_f32 v8, v8, s57, -v52
    v_fma_f32 v9, v9, s57, -v52
    v_fma_f32 v10, v10, s57, -v52
    v_fma_f32 v11, v11, s57, -v52
    v_fma_f32 v12, v12, s57, -v52
    v_fma_f32 v13, v13, s57, -v52
    v_fma_f32 v14, v14, s57, -v52
    v_fma_f32 v15, v15, s57, -v52
    v_exp_f32 v0, v0
    v_exp_f32 v1, v1
    v_exp_f32 v2, v2
    v_exp_f32 v3, v3
    v_exp_f32 v4, v4
    v_exp_f32 v5, v5
    v_exp_f32 v6, v6
    v_exp_f32 v7, v7
    v_exp_f32 v8, v8
    v_exp_f32 v9, v9
    v_exp_f32 v10, v10
    v_exp_f32 v11, v11
    v_exp_f32 v12, v12
    v_exp_f32 v13, v13
    v_exp_f32 v14, v14
    v_exp_f32 v15, v15
    v_add_f32 v58, v0, v1
    v_add_f32 v59, v2, v3
    v_add_f32 v58, v58, v4
    v_add_f32 v59, v59, v5
    v_add_f32 v58, v58, v6
    v_add_f32 v59, v59, v7
    v_add_f32 v58, v58, v8
    v_add_f32 v59, v59, v9
    v_add_f32 v58, v58, v10
    v_add_f32 v59, v59, v11
    v_add_f32 v58, v58, v12
    v_add_f32 v59, v59, v13
    v_add_f32 v58, v58, v14
    v_add_f32 v59, v59, v15
    v_add_f32 v58, v58, v59
    v_add_f32 v54, v54, v58
    v_cvt_pk_bf16_f32 v0, v0, v1
    v_cvt_pk_bf16_f32 v1, v2, v3
    v_cvt_pk_bf16_f32 v2, v4, v5
    v_cvt_pk_bf16_f32 v3, v6, v7
    v_cvt_pk_bf16_f32 v8, v8, v9
    v_cvt_pk_bf16_f32 v9, v10, v11
    v_cvt_pk_bf16_f32 v10, v12, v13
    v_cvt_pk_bf16_f32 v11, v14, v15
    s_waitcnt lgkmcnt(0)
    v_mfma_f32_32x32x16_bf16 v[128:143], a[32:35], v[0:3], v[128:143]
    s_add_u32 m0, s48, 8192
    s_waitcnt vmcnt(4)
    buffer_load_dwordx4 v36, s[36:39], s55 offen offset:0 nt lds
    v_max3_f32 v60, v16, v17, v18
    v_max3_f32 v60, v60, v19, v20
    v_max3_f32 v60, v60, v21, v22
    v_max3_f32 v60, v60, v23, v24
    v_mfma_f32_32x32x16_bf16 v[128:143], a[36:39], v[8:11], v[128:143]
    v_max3_f32 v60, v60, v25, v26
    v_max3_f32 v60, v60, v27, v28
    v_max3_f32 v60, v60, v29, v30
    v_max_f32 v60, v60, v31
    v_mov_b32 v61, v60
    s_nop 1
    v_permlane32_swap_b32 v60, v61
    v_mfma_f32_32x32x16_bf16 v[160:175], a[40:43], v[0:3], v[160:175]
    v_max_f32 v60, v60, v61
    v_sub_f32 v61, v60, v51
    v_cmp_lt_f32 vcc, s69, v61
    s_nop 1
    s_cbranch_vccnz L1_rs01
L1_rb01:
    s_waitcnt vmcnt(4)
    buffer_load_dwordx4 v36, s[36:39], s55 offen offset:1024 nt lds
    v_mfma_f32_32x32x16_bf16 v[160:175], a[44:47], v[8:11], v[160:175]
    v_fma_f32 v16, v16, s57, -v53
    v_fma_f32 v17, v17, s57, -v53
    v_fma_f32 v18, v18, s57, -v53
    v_fma_f32 v19, v19, s57, -v53
    v_fma_f32 v20, v20, s57, -v53
    v_fma_f32 v21, v21, s57, -v53
    v_mfma_f32_32x32x16_bf16 v[192:207], a[48:51], v[0:3], v[192:207]
    v_fma_f32 v22, v22, s57, -v53
    v_fma_f32 v23, v23, s57, -v53
    v_fma_f32 v24, v24, s57, -v53
    v_fma_f32 v25, v25, s57, -v53
    v_fma_f32 v26, v26, s57, -v53
    v_fma_f32 v27, v27, s57, -v53
    v_mfma_f32_32x32x16_bf16 v[192:207], a[52:55], v[8:11], v[192:207]
    v_fma_f32 v28, v28, s57, -v53
    v_fma_f32 v29, v29, s57, -v53
    v_fma_f32 v30, v30, s57, -v53
    v_fma_f32 v31, v31, s57, -v53
    s_waitcnt vmcnt(4)
    buffer_load_dwordx4 v36, s[36:39], s55 offen offset:2048 nt lds
    v_mfma_f32_32x32x16_bf16 v[224:239], a[56:59], v[0:3], v[224:239]
    v_exp_f32 v16, v16
    v_exp_f32 v17, v17
    v_exp_f32 v18, v18
    v_mfma_f32_32x32x16_bf16 v[224:239], a[60:63], v[8:11], v[224:239]
    v_exp_f32 v19, v19
    v_exp_f32 v20, v20
    v_exp_f32 v21, v21
    v_exp_f32 v22, v22
    v_exp_f32 v23, v23
    s_waitcnt vmcnt(4)
    buffer_load_dwordx4 v36, s[36:39], s55 offen offset:3072 nt lds
    v_exp_f32 v24, v24
    v_exp_f32 v25, v25
    v_exp_f32 v26, v26
    v_exp_f32 v27, v27
    v_exp_f32 v28, v28
    v_exp_f32 v29, v29
    v_exp_f32 v30, v30
    v_exp_f32 v31, v31
    s_add_u32 m0, s48, 12288
    s_waitcnt vmcnt(4)
    buffer_load_dwordx4 v36, s[36:39], s56 offen offset:0 nt lds
    v_add_f32 v60, v16, v17
    v_add_f32 v61, v18, v19
    v_add_f32 v60, v60, v20
    v_add_f32 v61, v61, v21
    v_add_f32 v60, v60, v22
    v_add_f32 v61, v61, v23
    v_add_f32 v60, v60, v24
    v_add_f32 v61, v61, v25
    v_add_f32 v60, v60, v26
    v_add_f32 v61, v61, v27
    v_add_f32 v60, v60, v28
    v_add_f32 v61, v61, v29
    v_add_f32 v60, v60, v30
    v_add_f32 v61, v61, v31
    v_add_f32 v60, v60, v61
    v_add_f32 v55, v55, v60
    v_cvt_pk_bf16_f32 v16, v16, v17
    v_cvt_pk_bf16_f32 v17, v18, v19
    v_cvt_pk_bf16_f32 v18, v20, v21
    v_cvt_pk_bf16_f32 v19, v22, v23
    v_cvt_pk_bf16_f32 v24, v24, v25
    v_cvt_pk_bf16_f32 v25, v26, v27
    v_cvt_pk_bf16_f32 v26, v28, v29
    v_cvt_pk_bf16_f32 v27, v30, v31
    v_mfma_f32_32x32x16_bf16 v[144:159], a[32:35], v[16:19], v[144:159]
    s_waitcnt vmcnt(4)
    buffer_load_dwordx4 v36, s[36:39], s56 offen offset:1024 nt lds
    v_mfma_f32_32x32x16_bf16 v[144:159], a[36:39], v[24:27], v[144:159]
    v_mfma_f32_32x32x16_bf16 v[176:191], a[40:43], v[16:19], v[176:191]
    s_waitcnt vmcnt(4)
    buffer_load_dwordx4 v36, s[36:39], s56 offen offset:2048 nt lds
    v_mfma_f32_32x32x16_bf16 v[176:191], a[44:47], v[24:27], v[176:191]
    v_mfma_f32_32x32x16_bf16 v[208:223], a[48:51], v[16:19], v[208:223]
    s_waitcnt vmcnt(4)
    buffer_load_dwordx4 v36, s[36:39], s56 offen offset:3072 nt lds
    v_mfma_f32_32x32x16_bf16 v[208:223], a[52:55], v[24:27], v[208:223]
    v_mfma_f32_32x32x16_bf16 v[240:255], a[56:59], v[16:19], v[240:255]
    v_mfma_f32_32x32x16_bf16 v[240:255], a[60:63], v[24:27], v[240:255]
    s_add_u32 s63, s63, 1
    s_and_b32 s63, s63, 15
    s_lshl_b32 s55, s63, 13
    s_add_u32 s56, s55, 4096
    s_waitcnt vmcnt(24)
    ds_read_b128 a[0:3], v38 offset:16384
    ds_read_b128 a[4:7], v39 offset:16384
    ds_read_b128 a[8:11], v40 offset:16384
    ds_read_b128 a[12:15], v41 offset:16384
    ds_read_b128 a[16:19], v42 offset:16384
    ds_read_b128 a[20:23], v43 offset:16384
    ds_read_b128 a[24:27], v44 offset:16384
    ds_read_b128 a[28:31], v45 offset:16384
    s_add_u32 s58, s54, 3
    s_cmp_lt_u32 s58, 16
    s_cselect_b32 s34, 131072, 0
    s_cselect_b32 s38, 131072, 0
    s_waitcnt lgkmcnt(0)
    v_mfma_f32_32x32x16_bf16 v[0:15], a[0:3], v[64:67], 0
    s_add_u32 m0, s48, 16384
    s_waitcnt vmcnt(4)
    buffer_load_dwordx4 v32, s[32:35], s55 offen offset:0 nt lds
    v_mfma_f32_32x32x16_bf16 v[0:15], a[4:7], v[68:71], v[0:15]
    v_mfma_f32_32x32x16_bf16 v[0:15], a[8:11], v[72:75], v[0:15]
    s_waitcnt vmcnt(4)
    buffer_load_dwordx4 v33, s[32:35], s55 offen offset:1024 nt lds
    v_mfma_f32_32x32x16_bf16 v[0:15], a[12:15], v[76:79], v[0:15]
    v_mfma_f32_32x32x16_bf16 v[0:15], a[16:19], v[80:83], v[0:15]
    s_waitcnt vmcnt(4)
    buffer_load_dwordx4 v34, s[32:35], s55 offen offset:2048 nt lds
    v_mfma_f32_32x32x16_bf16 v[0:15], a[20:23], v[84:87], v[0:15]
    v_mfma_f32_32x32x16_bf16 v[0:15], a[24:27], v[88:91], v[0:15]
    s_waitcnt vmcnt(4)
    buffer_load_dwordx4 v35, s[32:35], s55 offen offset:3072 nt lds
    v_mfma_f32_32x32x16_bf16 v[0:15], a[28:31], v[92:95], v[0:15]
    s_waitcnt vmcnt(20)
    v_mfma_f32_32x32x16_bf16 v[16:31], a[0:3], v[96:99], 0
    ds_read_b64_tr_b16 a[32:33], v46 offset:24576
    ds_read_b64_tr_b16 a[34:35], v46 offset:26624
    ds_read_b64_tr_b16 a[36:37], v46 offset:28672
    ds_read_b64_tr_b16 a[38:39], v46 offset:30720
    v_mfma_f32_32x32x16_bf16 v[16:31], a[4:7], v[100:103], v[16:31]
    ds_read_b64_tr_b16 a[40:41], v47 offset:24576
    ds_read_b64_tr_b16 a[42:43], v47 offset:26624
    ds_read_b64_tr_b16 a[44:45], v47 offset:28672
    ds_read_b64_tr_b16 a[46:47], v47 offset:30720
    v_mfma_f32_32x32x16_bf16 v[16:31], a[8:11], v[104:107], v[16:31]
    ds_read_b64_tr_b16 a[48:49], v48 offset:24576
    ds_read_b64_tr_b16 a[50:51], v48 offset:26624
    ds_read_b64_tr_b16 a[52:53], v48 offset:28672
    ds_read_b64_tr_b16 a[54:55], v48 offset:30720
    s_add_u32 m0, s48, 20480
    s_waitcnt vmcnt(4)
    buffer_load_dwordx4 v32, s[32:35], s56 offen offset:0 nt lds
    v_mfma_f32_32x32x16_bf16 v[16:31], a[12:15], v[108:111], v[16:31]
    ds_read_b64_tr_b16 a[56:57], v49 offset:24576
    ds_read_b64_tr_b16 a[58:59], v49 offset:26624
    ds_read_b64_tr_b16 a[60:61], v49 offset:28672
    ds_read_b64_tr_b16 a[62:63], v49 offset:30720
    s_waitcnt vmcnt(4)
    buffer_load_dwordx4 v33, s[32:35], s56 offen offset:1024 nt lds
    v_mfma_f32_32x32x16_bf16 v[16:31], a[16:19], v[112:115], v[16:31]
    s_waitcnt vmcnt(4)
    buffer_load_dwordx4 v34, s[32:35], s56 offen offset:2048 nt lds
    v_max3_f32 v58, v0, v1, v2
    v_max3_f32 v58, v58, v3, v4
    v_mfma_f32_32x32x16_bf16 v[16:31], a[20:23], v[116:119], v[16:31]
    v_max3_f32 v58, v58, v5, v6
    v_max3_f32 v58, v58, v7, v8
    s_waitcnt vmcnt(4)
    buffer_load_dwordx4 v35, s[32:35], s56 offen offset:3072 nt lds
    v_mfma_f32_32x32x16_bf16 v[16:31], a[24:27], v[120:123], v[16:31]
    v_max3_f32 v58, v58, v9, v10
    v_max3_f32 v58, v58, v11, v12
    v_max3_f32 v58, v58, v13, v14
    v_max_f32 v58, v58, v15
    v_mfma_f32_32x32x16_bf16 v[16:31], a[28:31], v[124:127], v[16:31]
    v_mov_b32 v59, v58
    s_nop 1
    v_permlane32_swap_b32 v58, v59
    v_max_f32 v58, v58, v59
    v_sub_f32 v59, v58, v50
    v_cmp_lt_f32 vcc, s69, v59
    s_nop 1
    s_cbranch_vccnz L1_rs10
L1_rb10:
    v_fma_f32 v0, v0, s57, -v52
    v_fma_f32 v1, v1, s57, -v52
    v_fma_f32 v2, v2, s57, -v52
    v_fma_f32 v3, v3, s57, -v52
    v_fma_f32 v4, v4, s57, -v52
    v_fma_f32 v5, v5, s57, -v52
    v_fma_f32 v6, v6, s57, -v52
    v_fma_f32 v7, v7, s57, -v52
    v_fma_f32 v8, v8, s57, -v52
    v_fma_f32 v9, v9, s57, -v52
    v_fma_f32 v10, v10, s57, -v52
    v_fma_f32 v11, v11, s57, -v52
    v_fma_f32 v12, v12, s57, -v52
    v_fma_f32 v13, v13, s57, -v52
    v_fma_f32 v14, v14, s57, -v52
    v_fma_f32 v15, v15, s57, -v52
    v_exp_f32 v0, v0
    v_exp_f32 v1, v1
    v_exp_f32 v2, v2
    v_exp_f32 v3, v3
    v_exp_f32 v4, v4
    v_exp_f32 v5, v5
    v_exp_f32 v6, v6
    v_exp_f32 v7, v7
    v_exp_f32 v8, v8
    v_exp_f32 v9, v9
    v_exp_f32 v10, v10
    v_exp_f32 v11, v11
    v_exp_f32 v12, v12
    v_exp_f32 v13, v13
    v_exp_f32 v14, v14
    v_exp_f32 v15, v15
    v_add_f32 v58, v0, v1
    v_add_f32 v59, v2, v3
    v_add_f32 v58, v58, v4
    v_add_f32 v59, v59, v5
    v_add_f32 v58, v58, v6
    v_add_f32 v59, v59, v7
    v_add_f32 v58, v58, v8
    v_add_f32 v59, v59, v9
    v_add_f32 v58, v58, v10
    v_add_f32 v59, v59, v11
    v_add_f32 v58, v58, v12
    v_add_f32 v59, v59, v13
    v_add_f32 v58, v58, v14
    v_add_f32 v59, v59, v15
    v_add_f32 v58, v58, v59
    v_add_f32 v54, v54, v58
    v_cvt_pk_bf16_f32 v0, v0, v1
    v_cvt_pk_bf16_f32 v1, v2, v3
    v_cvt_pk_bf16_f32 v2, v4, v5
    v_cvt_pk_bf16_f32 v3, v6, v7
    v_cvt_pk_bf16_f32 v8, v8, v9
    v_cvt_pk_bf16_f32 v9, v10, v11
    v_cvt_pk_bf16_f32 v10, v12, v13
    v_cvt_pk_bf16_f32 v11, v14, v15
    s_waitcnt lgkmcnt(0)
    v_mfma_f32_32x32x16_bf16 v[128:143], a[32:35], v[0:3], v[128:143]
    s_add_u32 m0, s48, 24576
    s_waitcnt vmcnt(4)
    buffer_load_dwordx4 v36, s[36:39], s55 offen offset:0 nt lds
    v_max3_f32 v60, v16, v17, v18
    v_max3_f32 v60, v60, v19, v20
    v_max3_f32 v60, v60, v21, v22
    v_max3_f32 v60, v60, v23, v24
    v_mfma_f32_32x32x16_bf16 v[128:143], a[36:39], v[8:11], v[128:143]
    v_max3_f32 v60, v60, v25, v26
    v_max3_f32 v60, v60, v27, v28
    v_max3_f32 v60, v60, v29, v30
    v_max_f32 v60, v60, v31
    v_mov_b32 v61, v60
    s_nop 1
    v_permlane32_swap_b32 v60, v61
    v_mfma_f32_32x32x16_bf16 v[160:175], a[40:43], v[0:3], v[160:175]
    v_max_f32 v60, v60, v61
    v_sub_f32 v61, v60, v51
    v_cmp_lt_f32 vcc, s69, v61
    s_nop 1
    s_cbranch_vccnz L1_rs11
L1_rb11:
    s_waitcnt vmcnt(4)
    buffer_load_dwordx4 v36, s[36:39], s55 offen offset:1024 nt lds
    v_mfma_f32_32x32x16_bf16 v[160:175], a[44:47], v[8:11], v[160:175]
    v_fma_f32 v16, v16, s57, -v53
    v_fma_f32 v17, v17, s57, -v53
    v_fma_f32 v18, v18, s57, -v53
    v_fma_f32 v19, v19, s57, -v53
    v_fma_f32 v20, v20, s57, -v53
    v_fma_f32 v21, v21, s57, -v53
    v_mfma_f32_32x32x16_bf16 v[192:207], a[48:51], v[0:3], v[192:207]
    v_fma_f32 v22, v22, s57, -v53
    v_fma_f32 v23, v23, s57, -v53
    v_fma_f32 v24, v24, s57, -v53
    v_fma_f32 v25, v25, s57, -v53
    v_fma_f32 v26, v26, s57, -v53
    v_fma_f32 v27, v27, s57, -v53
    v_mfma_f32_32x32x16_bf16 v[192:207], a[52:55], v[8:11], v[192:207]
    v_fma_f32 v28, v28, s57, -v53
    v_fma_f32 v29, v29, s57, -v53
    v_fma_f32 v30, v30, s57, -v53
    v_fma_f32 v31, v31, s57, -v53
    s_waitcnt vmcnt(4)
    buffer_load_dwordx4 v36, s[36:39], s55 offen offset:2048 nt lds
    v_mfma_f32_32x32x16_bf16 v[224:239], a[56:59], v[0:3], v[224:239]
    v_exp_f32 v16, v16
    v_exp_f32 v17, v17
    v_exp_f32 v18, v18
    v_mfma_f32_32x32x16_bf16 v[224:239], a[60:63], v[8:11], v[224:239]
    v_exp_f32 v19, v19
    v_exp_f32 v20, v20
    v_exp_f32 v21, v21
    v_exp_f32 v22, v22
    v_exp_f32 v23, v23
    s_waitcnt vmcnt(4)
    buffer_load_dwordx4 v36, s[36:39], s55 offen offset:3072 nt lds
    v_exp_f32 v24, v24
    v_exp_f32 v25, v25
    v_exp_f32 v26, v26
    v_exp_f32 v27, v27
    v_exp_f32 v28, v28
    v_exp_f32 v29, v29
    v_exp_f32 v30, v30
    v_exp_f32 v31, v31
    s_add_u32 m0, s48, 28672
    s_waitcnt vmcnt(4)
    buffer_load_dwordx4 v36, s[36:39], s56 offen offset:0 nt lds
    v_add_f32 v60, v16, v17
    v_add_f32 v61, v18, v19
    v_add_f32 v60, v60, v20
    v_add_f32 v61, v61, v21
    v_add_f32 v60, v60, v22
    v_add_f32 v61, v61, v23
    v_add_f32 v60, v60, v24
    v_add_f32 v61, v61, v25
    v_add_f32 v60, v60, v26
    v_add_f32 v61, v61, v27
    v_add_f32 v60, v60, v28
    v_add_f32 v61, v61, v29
    v_add_f32 v60, v60, v30
    v_add_f32 v61, v61, v31
    v_add_f32 v60, v60, v61
    v_add_f32 v55, v55, v60
    v_cvt_pk_bf16_f32 v16, v16, v17
    v_cvt_pk_bf16_f32 v17, v18, v19
    v_cvt_pk_bf16_f32 v18, v20, v21
    v_cvt_pk_bf16_f32 v19, v22, v23
    v_cvt_pk_bf16_f32 v24, v24, v25
    v_cvt_pk_bf16_f32 v25, v26, v27
    v_cvt_pk_bf16_f32 v26, v28, v29
    v_cvt_pk_bf16_f32 v27, v30, v31
    v_mfma_f32_32x32x16_bf16 v[144:159], a[32:35], v[16:19], v[144:159]
    s_waitcnt vmcnt(4)
    buffer_load_dwordx4 v36, s[36:39], s56 offen offset:1024 nt lds
    v_mfma_f32_32x32x16_bf16 v[144:159], a[36:39], v[24:27], v[144:159]
    v_mfma_f32_32x32x16_bf16 v[176:191], a[40:43], v[16:19], v[176:191]
    s_waitcnt vmcnt(4)
    buffer_load_dwordx4 v36, s[36:39], s56 offen offset:2048 nt lds
    v_mfma_f32_32x32x16_bf16 v[176:191], a[44:47], v[24:27], v[176:191]
    v_mfma_f32_32x32x16_bf16 v[208:223], a[48:51], v[16:19], v[208:223]
    s_waitcnt vmcnt(4)
    buffer_load_dwordx4 v36, s[36:39], s56 offen offset:3072 nt lds
    v_mfma_f32_32x32x16_bf16 v[208:223], a[52:55], v[24:27], v[208:223]
    v_mfma_f32_32x32x16_bf16 v[240:255], a[56:59], v[16:19], v[240:255]
    v_mfma_f32_32x32x16_bf16 v[240:255], a[60:63], v[24:27], v[240:255]
    s_add_u32 s63, s63, 1
    s_and_b32 s63, s63, 15
    s_lshl_b32 s55, s63, 13
    s_add_u32 s56, s55, 4096
    s_add_u32 s54, s54, 2
    s_cmp_lt_u32 s54, 16
    s_cbranch_scc1 L1_p2loop
    s_load_dwordx2 s[4:5], s[0:1], 32
    s_load_dwordx2 s[6:7], s[0:1], 72
    s_load_dwordx2 s[8:9], s[0:1], 80
    s_load_dwordx2 s[70:71], s[0:1], 96
    s_cmp_eq_u32 s22, 0
    s_cbranch_scc0 L1_noi
    v_mbcnt_lo_u32_b32 v30, -1, 0
    v_lshlrev_b32 v30, 7, v30
    s_mov_b64 exec, 3
    buffer_load_dword v31, v30, s[64:67], 0 offen sc1
    s_mov_b64 exec, -1
L1_noi:
    v_mov_b32 v58, v54
    v_mov_b32 v59, v54
    s_nop 1
    v_permlane32_swap_b32 v58, v59
    v_add_f32 v58, v58, v59
    v_rcp_f32 v56, v58
    v_mov_b32 v60, v55
    v_mov_b32 v61, v55
    s_nop 1
    v_permlane32_swap_b32 v60, v61
    v_add_f32 v60, v60, v61
    v_rcp_f32 v57, v60
    s_lshl_b32 s58, s44, 18
    s_lshl_b32 s59, s46, 13
    s_add_u32 s58, s58, s59
    s_add_u32 s59, s58, 131072
    v_pk_mul_f32 v[128:129], v[128:129], v[56:57] op_sel_hi:[1,0]
    v_pk_mul_f32 v[130:131], v[130:131], v[56:57] op_sel_hi:[1,0]
    v_pk_mul_f32 v[132:133], v[132:133], v[56:57] op_sel_hi:[1,0]
    v_pk_mul_f32 v[134:135], v[134:135], v[56:57] op_sel_hi:[1,0]
    v_pk_mul_f32 v[136:137], v[136:137], v[56:57] op_sel_hi:[1,0]
    v_pk_mul_f32 v[138:139], v[138:139], v[56:57] op_sel_hi:[1,0]
    v_pk_mul_f32 v[140:141], v[140:141], v[56:57] op_sel_hi:[1,0]
    v_pk_mul_f32 v[142:143], v[142:143], v[56:57] op_sel_hi:[1,0]
    v_cvt_pk_bf16_f32 v128, v128, v129
    v_cvt_pk_bf16_f32 v129, v130, v131
    v_cvt_pk_bf16_f32 v130, v132, v133
    v_cvt_pk_bf16_f32 v131, v134, v135
    v_cvt_pk_bf16_f32 v136, v136, v137
    v_cvt_pk_bf16_f32 v137, v138, v139
    v_cvt_pk_bf16_f32 v138, v140, v141
    v_cvt_pk_bf16_f32 v139, v142, v143
    buffer_store_dwordx4 v[128:131], v37, s[40:43], s58 offen offset:0 sc1
    buffer_store_dwordx4 v[136:139], v37, s[40:43], s58 offen offset:1024 sc1
    v_pk_mul_f32 v[160:161], v[160:161], v[56:57] op_sel_hi:[1,0]
    v_pk_mul_f32 v[162:163], v[162:163], v[56:57] op_sel_hi:[1,0]
    v_pk_mul_f32 v[164:165], v[164:165], v[56:57] op_sel_hi:[1,0]
    v_pk_mul_f32 v[166:167], v[166:167], v[56:57] op_sel_hi:[1,0]
    v_pk_mul_f32 v[168:169], v[168:169], v[56:57] op_sel_hi:[1,0]
    v_pk_mul_f32 v[170:171], v[170:171], v[56:57] op_sel_hi:[1,0]
    v_pk_mul_f32 v[172:173], v[172:173], v[56:57] op_sel_hi:[1,0]
    v_pk_mul_f32 v[174:175], v[174:175], v[56:57] op_sel_hi:[1,0]
    v_cvt_pk_bf16_f32 v160, v160, v161
    v_cvt_pk_bf16_f32 v161, v162, v163
    v_cvt_pk_bf16_f32 v162, v164, v165
    v_cvt_pk_bf16_f32 v163, v166, v167
    v_cvt_pk_bf16_f32 v168, v168, v169
    v_cvt_pk_bf16_f32 v169, v170, v171
    v_cvt_pk_bf16_f32 v170, v172, v173
    v_cvt_pk_bf16_f32 v171, v174, v175
    buffer_store_dwordx4 v[160:163], v37, s[40:43], s58 offen offset:2048 sc1
    buffer_store_dwordx4 v[168:171], v37, s[40:43], s58 offen offset:3072 sc1
    v_pk_mul_f32 v[192:193], v[192:193], v[56:57] op_sel_hi:[1,0]
    v_pk_mul_f32 v[194:195], v[194:195], v[56:57] op_sel_hi:[1,0]
    v_pk_mul_f32 v[196:197], v[196:197], v[56:57] op_sel_hi:[1,0]
    v_pk_mul_f32 v[198:199], v[198:199], v[56:57] op_sel_hi:[1,0]
    v_pk_mul_f32 v[200:201], v[200:201], v[56:57] op_sel_hi:[1,0]
    v_pk_mul_f32 v[202:203], v[202:203], v[56:57] op_sel_hi:[1,0]
    v_pk_mul_f32 v[204:205], v[204:205], v[56:57] op_sel_hi:[1,0]
    v_pk_mul_f32 v[206:207], v[206:207], v[56:57] op_sel_hi:[1,0]
    v_cvt_pk_bf16_f32 v192, v192, v193
    v_cvt_pk_bf16_f32 v193, v194, v195
    v_cvt_pk_bf16_f32 v194, v196, v197
    v_cvt_pk_bf16_f32 v195, v198, v199
    v_cvt_pk_bf16_f32 v200, v200, v201
    v_cvt_pk_bf16_f32 v201, v202, v203
    v_cvt_pk_bf16_f32 v202, v204, v205
    v_cvt_pk_bf16_f32 v203, v206, v207
    buffer_store_dwordx4 v[192:195], v37, s[40:43], s59 offen offset:0 sc1
    buffer_store_dwordx4 v[200:203], v37, s[40:43], s59 offen offset:1024 sc1
    v_pk_mul_f32 v[224:225], v[224:225], v[56:57] op_sel_hi:[1,0]
    v_pk_mul_f32 v[226:227], v[226:227], v[56:57] op_sel_hi:[1,0]
    v_pk_mul_f32 v[228:229], v[228:229], v[56:57] op_sel_hi:[1,0]
    v_pk_mul_f32 v[230:231], v[230:231], v[56:57] op_sel_hi:[1,0]
    v_pk_mul_f32 v[232:233], v[232:233], v[56:57] op_sel_hi:[1,0]
    v_pk_mul_f32 v[234:235], v[234:235], v[56:57] op_sel_hi:[1,0]
    v_pk_mul_f32 v[236:237], v[236:237], v[56:57] op_sel_hi:[1,0]
    v_pk_mul_f32 v[238:239], v[238:239], v[56:57] op_sel_hi:[1,0]
    v_cvt_pk_bf16_f32 v224, v224, v225
    v_cvt_pk_bf16_f32 v225, v226, v227
    v_cvt_pk_bf16_f32 v226, v228, v229
    v_cvt_pk_bf16_f32 v227, v230, v231
    v_cvt_pk_bf16_f32 v232, v232, v233
    v_cvt_pk_bf16_f32 v233, v234, v235
    v_cvt_pk_bf16_f32 v234, v236, v237
    v_cvt_pk_bf16_f32 v235, v238, v239
    buffer_store_dwordx4 v[224:227], v37, s[40:43], s59 offen offset:2048 sc1
    buffer_store_dwordx4 v[232:235], v37, s[40:43], s59 offen offset:3072 sc1
    s_add_u32 s58, s58, 4096
    s_add_u32 s59, s59, 4096
    v_pk_mul_f32 v[144:145], v[144:145], v[56:57] op_sel:[0,1] op_sel_hi:[1,1]
    v_pk_mul_f32 v[146:147], v[146:147], v[56:57] op_sel:[0,1] op_sel_hi:[1,1]
    v_pk_mul_f32 v[148:149], v[148:149], v[56:57] op_sel:[0,1] op_sel_hi:[1,1]
    v_pk_mul_f32 v[150:151], v[150:151], v[56:57] op_sel:[0,1] op_sel_hi:[1,1]
    v_pk_mul_f32 v[152:153], v[152:153], v[56:57] op_sel:[0,1] op_sel_hi:[1,1]
    v_pk_mul_f32 v[154:155], v[154:155], v[56:57] op_sel:[0,1] op_sel_hi:[1,1]
    v_pk_mul_f32 v[156:157], v[156:157], v[56:57] op_sel:[0,1] op_sel_hi:[1,1]
    v_pk_mul_f32 v[158:159], v[158:159], v[56:57] op_sel:[0,1] op_sel_hi:[1,1]
    v_cvt_pk_bf16_f32 v144, v144, v145
    v_cvt_pk_bf16_f32 v145, v146, v147
    v_cvt_pk_bf16_f32 v146, v148, v149
    v_cvt_pk_bf16_f32 v147, v150, v151
    v_cvt_pk_bf16_f32 v152, v152, v153
    v_cvt_pk_bf16_f32 v153, v154, v155
    v_cvt_pk_bf16_f32 v154, v156, v157
    v_cvt_pk_bf16_f32 v155, v158, v159
    buffer_store_dwordx4 v[144:147], v37, s[40:43], s58 offen offset:0 sc1
    buffer_store_dwordx4 v[152:155], v37, s[40:43], s58 offen offset:1024 sc1
    v_pk_mul_f32 v[176:177], v[176:177], v[56:57] op_sel:[0,1] op_sel_hi:[1,1]
    v_pk_mul_f32 v[178:179], v[178:179], v[56:57] op_sel:[0,1] op_sel_hi:[1,1]
    v_pk_mul_f32 v[180:181], v[180:181], v[56:57] op_sel:[0,1] op_sel_hi:[1,1]
    v_pk_mul_f32 v[182:183], v[182:183], v[56:57] op_sel:[0,1] op_sel_hi:[1,1]
    v_pk_mul_f32 v[184:185], v[184:185], v[56:57] op_sel:[0,1] op_sel_hi:[1,1]
    v_pk_mul_f32 v[186:187], v[186:187], v[56:57] op_sel:[0,1] op_sel_hi:[1,1]
    v_pk_mul_f32 v[188:189], v[188:189], v[56:57] op_sel:[0,1] op_sel_hi:[1,1]
    v_pk_mul_f32 v[190:191], v[190:191], v[56:57] op_sel:[0,1] op_sel_hi:[1,1]
    v_cvt_pk_bf16_f32 v176, v176, v177
    v_cvt_pk_bf16_f32 v177, v178, v179
    v_cvt_pk_bf16_f32 v178, v180, v181
    v_cvt_pk_bf16_f32 v179, v182, v183
    v_cvt_pk_bf16_f32 v184, v184, v185
    v_cvt_pk_bf16_f32 v185, v186, v187
    v_cvt_pk_bf16_f32 v186, v188, v189
    v_cvt_pk_bf16_f32 v187, v190, v191
    buffer_store_dwordx4 v[176:179], v37, s[40:43], s58 offen offset:2048 sc1
    buffer_store_dwordx4 v[184:187], v37, s[40:43], s58 offen offset:3072 sc1
    v_pk_mul_f32 v[208:209], v[208:209], v[56:57] op_sel:[0,1] op_sel_hi:[1,1]
    v_pk_mul_f32 v[210:211], v[210:211], v[56:57] op_sel:[0,1] op_sel_hi:[1,1]
    v_pk_mul_f32 v[212:213], v[212:213], v[56:57] op_sel:[0,1] op_sel_hi:[1,1]
    v_pk_mul_f32 v[214:215], v[214:215], v[56:57] op_sel:[0,1] op_sel_hi:[1,1]
    v_pk_mul_f32 v[216:217], v[216:217], v[56:57] op_sel:[0,1] op_sel_hi:[1,1]
    v_pk_mul_f32 v[218:219], v[218:219], v[56:57] op_sel:[0,1] op_sel_hi:[1,1]
    v_pk_mul_f32 v[220:221], v[220:221], v[56:57] op_sel:[0,1] op_sel_hi:[1,1]
    v_pk_mul_f32 v[222:223], v[222:223], v[56:57] op_sel:[0,1] op_sel_hi:[1,1]
    v_cvt_pk_bf16_f32 v208, v208, v209
    v_cvt_pk_bf16_f32 v209, v210, v211
    v_cvt_pk_bf16_f32 v210, v212, v213
    v_cvt_pk_bf16_f32 v211, v214, v215
    v_cvt_pk_bf16_f32 v216, v216, v217
    v_cvt_pk_bf16_f32 v217, v218, v219
    v_cvt_pk_bf16_f32 v218, v220, v221
    v_cvt_pk_bf16_f32 v219, v222, v223
    buffer_store_dwordx4 v[208:211], v37, s[40:43], s59 offen offset:0 sc1
    buffer_store_dwordx4 v[216:219], v37, s[40:43], s59 offen offset:1024 sc1
    v_pk_mul_f32 v[240:241], v[240:241], v[56:57] op_sel:[0,1] op_sel_hi:[1,1]
    v_pk_mul_f32 v[242:243], v[242:243], v[56:57] op_sel:[0,1] op_sel_hi:[1,1]
    v_pk_mul_f32 v[244:245], v[244:245], v[56:57] op_sel:[0,1] op_sel_hi:[1,1]
    v_pk_mul_f32 v[246:247], v[246:247], v[56:57] op_sel:[0,1] op_sel_hi:[1,1]
    v_pk_mul_f32 v[248:249], v[248:249], v[56:57] op_sel:[0,1] op_sel_hi:[1,1]
    v_pk_mul_f32 v[250:251], v[250:251], v[56:57] op_sel:[0,1] op_sel_hi:[1,1]
    v_pk_mul_f32 v[252:253], v[252:253], v[56:57] op_sel:[0,1] op_sel_hi:[1,1]
    v_pk_mul_f32 v[254:255], v[254:255], v[56:57] op_sel:[0,1] op_sel_hi:[1,1]
    v_cvt_pk_bf16_f32 v240, v240, v241
    v_cvt_pk_bf16_f32 v241, v242, v243
    v_cvt_pk_bf16_f32 v242, v244, v245
    v_cvt_pk_bf16_f32 v243, v246, v247
    v_cvt_pk_bf16_f32 v248, v248, v249
    v_cvt_pk_bf16_f32 v249, v250, v251
    v_cvt_pk_bf16_f32 v250, v252, v253
    v_cvt_pk_bf16_f32 v251, v254, v255
    buffer_store_dwordx4 v[240:243], v37, s[40:43], s59 offen offset:2048 sc1
    buffer_store_dwordx4 v[248:251], v37, s[40:43], s59 offen offset:3072 sc1
    s_mov_b32 s24, s22
    v_mbcnt_lo_u32_b32 v1, -1, 0
    v_mbcnt_hi_u32_b32 v1, -1, v1
    s_and_b32 s32, s2, 7
    s_lshr_b32 s33, s2, 3
    s_lshr_b32 s25, s32, 2
    s_lshr_b32 s26, s33, 2
    s_and_b32 s27, s32, 1
    s_lshl_b32 s27, s27, 2
    s_and_b32 s35, s33, 3
    s_add_u32 s27, s27, s35
    s_bfe_u32 s34, s32, 0x10001
    s_lshl_b32 s31, s24, 12
    v_lshrrev_b32 v12, 4, v1
    v_and_b32 v13, 15, v1
    v_lshlrev_b32 v14, 1, v12
    v_xor_b32 v13, v13, v14
    v_lshlrev_b32 v13, 4, v13
    v_lshl_add_u32 v13, v12, 11, v13
    s_lshl_b32 s32, s24, 15
    v_add_u32 v13, s32, v13
    v_xor_b32 v14, 128, v13
    v_add_u32 v2, 0, v13
    v_add_u32 v3, 7168, v14
    v_add_u32 v4, 14336, v13
    v_add_u32 v5, 21504, v14
    v_lshlrev_b32 v6, 4, v1
    v_lshrrev_b32 v12, 5, v1
    v_bfe_u32 v13, v1, 4, 1
    v_lshlrev_b32 v12, 10, v12
    v_lshl_add_u32 v12, v13, 9, v12
    v_and_b32 v13, 15, v1
    v_lshl_add_u32 v18, v13, 4, v12
    v_add_u32 v19, 256, v18
    v_bfe_u32 v12, v1, 2, 2
    v_bfe_u32 v13, v1, 4, 1
    v_lshl_add_u32 v12, v13, 2, v12
    v_lshrrev_b32 v13, 5, v1
    v_lshl_add_u32 v13, v13, 4, v12
    v_lshlrev_b32 v13, 8, v13
    v_lshl_add_u32 v13, v12, 5, v13
    v_and_b32 v12, 3, v1
    v_lshl_add_u32 v13, v12, 3, v13
    s_lshl_b32 s32, s34, 7
    v_xor_b32 v52, s32, v13
    v_xor_b32 v53, 32, v52
    v_xor_b32 v54, 64, v52
    v_xor_b32 v55, 96, v52
    v_xor_b32 v56, 128, v52
    v_xor_b32 v57, 160, v52
    v_xor_b32 v58, 192, v52
    v_xor_b32 v59, 224, v52
    v_and_b32 v12, 31, v1
    v_lshrrev_b32 v13, 5, v1
    v_lshlrev_b32 v13, 4, v13
    v_lshl_add_u32 v7, v12, 12, v13
    v_and_b32 v12, 7, v1
    v_lshlrev_b32 v12, 3, v12
    v_bfe_u32 v13, v1, 3, 1
    v_add_u32 v12, v12, v13
    v_lshlrev_b32 v12, 9, v12
    v_bfe_u32 v13, v1, 4, 1
    v_lshl_add_u32 v17, v13, 7, v12
    s_waitcnt lgkmcnt(0)
    s_cmp_eq_u32 s25, 0
    s_cselect_b32 s4, s4, s6
    s_cselect_b32 s5, s5, s7
    s_lshl_b32 s32, s27, 8
    s_add_u32 s12, s4, s32
    s_addc_u32 s13, s5, 0
    s_sub_u32 s14, 8388608, s32
    s_mov_b32 s15, 0x00020000
    s_lshl_b32 s33, s26, 2
    s_add_u32 s33, s33, s24
    s_lshl_b32 s33, s33, 12
    s_lshl_b32 s32, s25, 23
    s_add_u32 s32, s32, s33
    s_add_u32 s16, s70, s32
    s_addc_u32 s17, s71, 0
    s_sub_u32 s18, 8388608, s33
    s_mov_b32 s19, 0x00020000
    s_lshl_b32 s29, s34, 22
    s_add_u32 s32, s26, s27
    s_and_b32 s32, s32, 3
    s_mov_b32 s80, 0x03010002
    s_mov_b32 s81, 0x07050406
    s_mov_b32 s82, 0x0b09080a
    s_mov_b32 s83, 0x0f0d0c0e
    s_mov_b32 s84, 0x13111012
    s_mov_b32 s85, 0x17151416
    s_mov_b32 s86, 0x1b19181a
    s_mov_b32 s87, 0x1f1d1c1e
    s_cmp_eq_u32 s32, 1
    s_cselect_b32 s80, 0x02010300, s80
    s_cselect_b32 s81, 0x06050704, s81
    s_cselect_b32 s82, 0x0a090b08, s82
    s_cselect_b32 s83, 0x0e0d0f0c, s83
    s_cselect_b32 s84, 0x12111310, s84
    s_cselect_b32 s85, 0x16151714, s85
    s_cselect_b32 s86, 0x1a191b18, s86
    s_cselect_b32 s87, 0x1e1d1f1c, s87
    s_cmp_eq_u32 s32, 2
    s_cselect_b32 s80, 0x02040100, s80
    s_cselect_b32 s81, 0x06080503, s81
    s_cselect_b32 s82, 0x0a0c0907, s82
    s_cselect_b32 s83, 0x0e100d0b, s83
    s_cselect_b32 s84, 0x1214110f, s84
    s_cselect_b32 s85, 0x16181513, s85
    s_cselect_b32 s86, 0x1a1c1917, s86
    s_cselect_b32 s87, 0x1f1e1d1b, s87
    s_cmp_eq_u32 s32, 3
    s_cselect_b32 s80, 0x05020100, s80
    s_cselect_b32 s81, 0x09060403, s81
    s_cselect_b32 s82, 0x0d0a0807, s82
    s_cselect_b32 s83, 0x110e0c0b, s83
    s_cselect_b32 s84, 0x1512100f, s84
    s_cselect_b32 s85, 0x19161413, s85
    s_cselect_b32 s86, 0x1d1a1817, s86
    s_cselect_b32 s87, 0x1f1e1c1b, s87
    s_mov_b32 s88, 0
    s_lshl_b32 s32, s26, 2
    s_add_u32 s32, s32, s24
    s_lshl_b32 s32, s32, 17
    s_lshl_b32 s33, s25, 11
    s_add_u32 s32, s32, s33
    s_lshl_b32 s33, s27, 8
    s_add_u32 s32, s32, s33
    s_lshl_b32 s33, s34, 7
    s_add_u32 s32, s32, s33
    s_add_u32 s72, s8, s32
    s_addc_u32 s73, s9, 0
    s_sub_u32 s74, 4194304, s32
    s_mov_b32 s75, 0x00020000
    s_add_u32 s36, s70, 50331648
    s_addc_u32 s37, s71, 0
    s_mov_b32 s38, 8388608
    s_mov_b32 s39, 0x00020000
    s_add_u32 s76, s70, 41943040
    s_addc_u32 s77, s71, 0
    s_mov_b32 s78, 262144
    s_mov_b32 s79, 0x00020000
    v_mov_b32 v64, 0
    v_mov_b32 v65, 0
    v_mov_b32 v66, 0
    v_mov_b32 v67, 0
    v_mov_b32 v68, 0
    v_mov_b32 v69, 0
    v_mov_b32 v70, 0
    v_mov_b32 v71, 0
    v_mov_b32 v72, 0
    v_mov_b32 v73, 0
    v_mov_b32 v74, 0
    v_mov_b32 v75, 0
    v_mov_b32 v76, 0
    v_mov_b32 v77, 0
    v_mov_b32 v78, 0
    v_mov_b32 v79, 0
    v_mov_b32 v80, 0
    v_mov_b32 v81, 0
    v_mov_b32 v82, 0
    v_mov_b32 v83, 0
    v_mov_b32 v84, 0
    v_mov_b32 v85, 0
    v_mov_b32 v86, 0
    v_mov_b32 v87, 0
    v_mov_b32 v88, 0
    v_mov_b32 v89, 0
    v_mov_b32 v90, 0
    v_mov_b32 v91, 0
    v_mov_b32 v92, 0
    v_mov_b32 v93, 0
    v_mov_b32 v94, 0
    v_mov_b32 v95, 0
    v_mov_b32 v96, 0
    v_mov_b32 v97, 0
    v_mov_b32 v98, 0
    v_mov_b32 v99, 0
    v_mov_b32 v100, 0
    v_mov_b32 v101, 0
    v_mov_b32 v102, 0
    v_mov_b32 v103, 0
    v_mov_b32 v104, 0
    v_mov_b32 v105, 0
    v_mov_b32 v106, 0
    v_mov_b32 v107, 0
    v_mov_b32 v108, 0
    v_mov_b32 v109, 0
    v_mov_b32 v110, 0
    v_mov_b32 v111, 0
    v_mov_b32 v112, 0
    v_mov_b32 v113, 0
    v_mov_b32 v114, 0
    v_mov_b32 v115, 0
    v_mov_b32 v116, 0
    v_mov_b32 v117, 0
    v_mov_b32 v118, 0
    v_mov_b32 v119, 0
    v_mov_b32 v120, 0
    v_mov_b32 v121, 0
    v_mov_b32 v122, 0
    v_mov_b32 v123, 0
    v_mov_b32 v124, 0
    v_mov_b32 v125, 0
    v_mov_b32 v126, 0
    v_mov_b32 v127, 0
    s_lshl_b32 s32, s2, 2
    s_add_u32 s32, s32, s24
    s_lshl_b32 s32, s32, 7
    v_mov_b32 v12, 1
    v_mov_b32 v13, 0
    s_waitcnt vmcnt(0)
    s_mov_b64 exec, 1
    buffer_store_dword v12, v13, s[76:79], s32 offen sc1
    s_mov_b64 exec, -1
    s_barrier
    s_bfe_u32 s28, s80, 0x80000
    s_lshl_b32 s28, s28, 17
    s_add_u32 s28, s28, s29
    s_add_u32 m0, s31, 0
    s_nop 0
    buffer_load_dwordx4 v2, s[12:15], s28 offen offset:0 lds
    buffer_load_dwordx4 v3, s[12:15], s28 offen offset:1024 lds
    buffer_load_dwordx4 v4, s[12:15], s28 offen offset:2048 lds
    buffer_load_dwordx4 v5, s[12:15], s28 offen offset:3072 lds
    s_bfe_u32 s28, s80, 0x80008
    s_lshl_b32 s28, s28, 17
    s_add_u32 s28, s28, s29
    s_add_u32 m0, s31, 16384
    s_nop 0
    buffer_load_dwordx4 v2, s[12:15], s28 offen offset:0 lds
    buffer_load_dwordx4 v3, s[12:15], s28 offen offset:1024 lds
    buffer_load_dwordx4 v4, s[12:15], s28 offen offset:2048 lds
    buffer_load_dwordx4 v5, s[12:15], s28 offen offset:3072 lds
    s_bfe_u32 s28, s80, 0x80010
    s_lshl_b32 s28, s28, 17
    s_add_u32 s28, s28, s29
    s_add_u32 m0, s31, 32768
    s_nop 0
    buffer_load_dwordx4 v2, s[12:15], s28 offen offset:0 lds
    buffer_load_dwordx4 v3, s[12:15], s28 offen offset:1024 lds
    buffer_load_dwordx4 v4, s[12:15], s28 offen offset:2048 lds
    buffer_load_dwordx4 v5, s[12:15], s28 offen offset:3072 lds
    s_bfe_u32 s28, s80, 0x80018
    s_lshl_b32 s28, s28, 17
    s_add_u32 s28, s28, s29
    s_add_u32 m0, s31, 49152
    s_nop 0
    buffer_load_dwordx4 v2, s[12:15], s28 offen offset:0 lds
    buffer_load_dwordx4 v3, s[12:15], s28 offen offset:1024 lds
    buffer_load_dwordx4 v4, s[12:15], s28 offen offset:2048 lds
    buffer_load_dwordx4 v5, s[12:15], s28 offen offset:3072 lds
    s_cmp_eq_u32 s24, 0
    s_cbranch_scc0 L3_ready
    s_lshr_b32 s32, s26, 1
    s_lshl_b32 s32, s32, 6
    s_lshl_b32 s33, s25, 2
    s_add_u32 s32, s32, s33
    s_lshl_b32 s33, s34, 1
    s_add_u32 s32, s32, s33
    s_lshl_b32 s32, s32, 9
    s_and_b32 s33, s26, 1
    s_lshl_b32 s33, s33, 8
    s_add_u32 s32, s32, s33
    s_mov_b64 s[46:47], exec
    s_mov_b32 s52, 0
    s_mov_b64 exec, 3
L3_init:
    v_readlane_b32 s33, v31, 0
    v_readlane_b32 s35, v31, 1
    s_nop 3
    s_add_u32 s33, s33, s35
    s_and_b32 s33, s33, 255
    s_cmp_eq_u32 s33, 0
    s_cbranch_scc1 L3_inited
    buffer_load_dword v31, v30, s[64:67], 0 offen sc1
    s_add_u32 s52, s52, 1
    s_waitcnt vmcnt(0)
    s_cmp_lt_u32 s52, 0x20000
    s_cbranch_scc1 L3_init
L3_inited:
    s_mov_b32 exec_lo, -1
    s_mov_b32 exec_hi, 0
    s_mov_b32 s52, 0
L3_poll:
    buffer_load_dword v14, v17, s[76:79], s32 offen sc1
    s_add_u32 s52, s52, 1
    s_waitcnt vmcnt(0)
    v_cmp_eq_u32 vcc, 1, v14
    s_cmp_ge_u32 s52, 0x20000
    s_cbranch_scc1 L3_polled
    s_nop 1
    s_cmp_eq_u32 vcc_lo, -1
    s_cbranch_scc0 L3_poll
L3_polled:
    s_mov_b64 exec, s[46:47]
L3_ready:
    s_barrier
    s_bfe_u32 s28, s80, 0x80000
    s_lshl_b32 s28, s28, 17
    s_add_u32 s28, s28, s29
    buffer_load_dwordx4 v[128:131], v18, s[16:19], s28 offen offset:0 sc1
    buffer_load_dwordx4 v[132:135], v19, s[16:19], s28 offen offset:0 sc1
    buffer_load_dwordx4 v[136:139], v18, s[16:19], s28 offen offset:2048 sc1
    buffer_load_dwordx4 v[140:143], v19, s[16:19], s28 offen offset:2048 sc1
    s_bfe_u32 s28, s80, 0x80008
    s_lshl_b32 s28, s28, 17
    s_add_u32 s28, s28, s29
    buffer_load_dwordx4 v[144:147], v18, s[16:19], s28 offen offset:0 sc1
    buffer_load_dwordx4 v[148:151], v19, s[16:19], s28 offen offset:0 sc1
    buffer_load_dwordx4 v[152:155], v18, s[16:19], s28 offen offset:2048 sc1
    buffer_load_dwordx4 v[156:159], v19, s[16:19], s28 offen offset:2048 sc1
    s_bfe_u32 s28, s80, 0x80010
    s_lshl_b32 s28, s28, 17
    s_add_u32 s28, s28, s29
    buffer_load_dwordx4 v[160:163], v18, s[16:19], s28 offen offset:0 sc1
    buffer_load_dwordx4 v[164:167], v19, s[16:19], s28 offen offset:0 sc1
    buffer_load_dwordx4 v[168:171], v18, s[16:19], s28 offen offset:2048 sc1
    buffer_load_dwordx4 v[172:175], v19, s[16:19], s28 offen offset:2048 sc1
    s_bfe_u32 s28, s80, 0x80018
    s_lshl_b32 s28, s28, 17
    s_add_u32 s28, s28, s29
    buffer_load_dwordx4 v[176:179], v18, s[16:19], s28 offen offset:0 sc1
    buffer_load_dwordx4 v[180:183], v19, s[16:19], s28 offen offset:0 sc1
    buffer_load_dwordx4 v[184:187], v18, s[16:19], s28 offen offset:2048 sc1
    buffer_load_dwordx4 v[188:191], v19, s[16:19], s28 offen offset:2048 sc1
    s_mov_b32 s80, s81
    s_mov_b32 s81, s82
    s_mov_b32 s82, s83
    s_mov_b32 s83, s84
    s_mov_b32 s84, s85
    s_mov_b32 s85, s86
    s_mov_b32 s86, s87
    s_mov_b32 s87, s88
    s_waitcnt vmcnt(28)
    s_barrier
    ds_read_b64_tr_b16 a[0:1], v52 offset:0
    ds_read_b64_tr_b16 a[2:3], v52 offset:2048
    ds_read_b64_tr_b16 a[4:5], v53 offset:0
    ds_read_b64_tr_b16 a[6:7], v53 offset:2048
    ds_read_b64_tr_b16 a[8:9], v54 offset:0
    ds_read_b64_tr_b16 a[10:11], v54 offset:2048
    ds_read_b64_tr_b16 a[12:13], v55 offset:0
    ds_read_b64_tr_b16 a[14:15], v55 offset:2048
    ds_read_b64_tr_b16 a[16:17], v56 offset:0
    ds_read_b64_tr_b16 a[18:19], v56 offset:2048
    ds_read_b64_tr_b16 a[20:21], v57 offset:0
    ds_read_b64_tr_b16 a[22:23], v57 offset:2048
    ds_read_b64_tr_b16 a[24:25], v58 offset:0
    ds_read_b64_tr_b16 a[26:27], v58 offset:2048
    ds_read_b64_tr_b16 a[28:29], v59 offset:0
    ds_read_b64_tr_b16 a[30:31], v59 offset:2048
    ds_read_b64_tr_b16 a[32:33], v52 offset:8192
    ds_read_b64_tr_b16 a[34:35], v52 offset:10240
    ds_read_b64_tr_b16 a[36:37], v53 offset:8192
    ds_read_b64_tr_b16 a[38:39], v53 offset:10240
    ds_read_b64_tr_b16 a[40:41], v54 offset:8192
    ds_read_b64_tr_b16 a[42:43], v54 offset:10240
    ds_read_b64_tr_b16 a[44:45], v55 offset:8192
    ds_read_b64_tr_b16 a[46:47], v55 offset:10240
    ds_read_b64_tr_b16 a[48:49], v56 offset:8192
    ds_read_b64_tr_b16 a[50:51], v56 offset:10240
    ds_read_b64_tr_b16 a[52:53], v57 offset:8192
    ds_read_b64_tr_b16 a[54:55], v57 offset:10240
    ds_read_b64_tr_b16 a[56:57], v58 offset:8192
    ds_read_b64_tr_b16 a[58:59], v58 offset:10240
    ds_read_b64_tr_b16 a[60:61], v59 offset:8192
    ds_read_b64_tr_b16 a[62:63], v59 offset:10240
    s_waitcnt vmcnt(12) lgkmcnt(0)
    s_barrier
    v_mfma_f32_16x16x32_bf16 v[64:67], a[0:3], v[128:131], v[64:67]
    ds_read_b64_tr_b16 a[64:65], v52 offset:16384
    v_mfma_f32_16x16x32_bf16 v[68:71], a[0:3], v[132:135], v[68:71]
    ds_read_b64_tr_b16 a[66:67], v52 offset:18432
    v_mfma_f32_16x16x32_bf16 v[72:75], a[4:7], v[128:131], v[72:75]
    ds_read_b64_tr_b16 a[68:69], v53 offset:16384
    s_bfe_u32 s28, s80, 0x80000
    s_lshl_b32 s28, s28, 17
    s_add_u32 s28, s28, s29
    s_add_u32 m0, s31, 0
    s_nop 0
    buffer_load_dwordx4 v2, s[12:15], s28 offen offset:0 lds
    v_mfma_f32_16x16x32_bf16 v[76:79], a[4:7], v[132:135], v[76:79]
    ds_read_b64_tr_b16 a[70:71], v53 offset:18432
    v_mfma_f32_16x16x32_bf16 v[80:83], a[8:11], v[128:131], v[80:83]
    ds_read_b64_tr_b16 a[72:73], v54 offset:16384
    v_mfma_f32_16x16x32_bf16 v[84:87], a[8:11], v[132:135], v[84:87]
    ds_read_b64_tr_b16 a[74:75], v54 offset:18432
    v_mfma_f32_16x16x32_bf16 v[88:91], a[12:15], v[128:131], v[88:91]
    ds_read_b64_tr_b16 a[76:77], v55 offset:16384
    ds_read_b64_tr_b16 a[78:79], v55 offset:18432
    v_mfma_f32_16x16x32_bf16 v[92:95], a[12:15], v[132:135], v[92:95]
    ds_read_b64_tr_b16 a[80:81], v56 offset:16384
    v_mfma_f32_16x16x32_bf16 v[96:99], a[16:19], v[128:131], v[96:99]
    ds_read_b64_tr_b16 a[82:83], v56 offset:18432
    v_mfma_f32_16x16x32_bf16 v[100:103], a[16:19], v[132:135], v[100:103]
    ds_read_b64_tr_b16 a[84:85], v57 offset:16384
    v_mfma_f32_16x16x32_bf16 v[104:107], a[20:23], v[128:131], v[104:107]
    ds_read_b64_tr_b16 a[86:87], v57 offset:18432
    buffer_load_dwordx4 v3, s[12:15], s28 offen offset:1024 lds
    v_mfma_f32_16x16x32_bf16 v[108:111], a[20:23], v[132:135], v[108:111]
    ds_read_b64_tr_b16 a[88:89], v58 offset:16384
    v_mfma_f32_16x16x32_bf16 v[112:115], a[24:27], v[128:131], v[112:115]
    ds_read_b64_tr_b16 a[90:91], v58 offset:18432
    v_mfma_f32_16x16x32_bf16 v[116:119], a[24:27], v[132:135], v[116:119]
    ds_read_b64_tr_b16 a[92:93], v59 offset:16384
    ds_read_b64_tr_b16 a[94:95], v59 offset:18432
    v_mfma_f32_16x16x32_bf16 v[120:123], a[28:31], v[128:131], v[120:123]
    ds_read_b64_tr_b16 a[96:97], v52 offset:24576
    v_mfma_f32_16x16x32_bf16 v[124:127], a[28:31], v[132:135], v[124:127]
    ds_read_b64_tr_b16 a[98:99], v52 offset:26624
    v_mfma_f32_16x16x32_bf16 v[64:67], a[32:35], v[136:139], v[64:67]
    ds_read_b64_tr_b16 a[100:101], v53 offset:24576
    v_mfma_f32_16x16x32_bf16 v[68:71], a[32:35], v[140:143], v[68:71]
    ds_read_b64_tr_b16 a[102:103], v53 offset:26624
    v_mfma_f32_16x16x32_bf16 v[72:75], a[36:39], v[136:139], v[72:75]
    ds_read_b64_tr_b16 a[104:105], v54 offset:24576
    buffer_load_dwordx4 v4, s[12:15], s28 offen offset:2048 lds
    v_mfma_f32_16x16x32_bf16 v[76:79], a[36:39], v[140:143], v[76:79]
    ds_read_b64_tr_b16 a[106:107], v54 offset:26624
    v_mfma_f32_16x16x32_bf16 v[80:83], a[40:43], v[136:139], v[80:83]
    ds_read_b64_tr_b16 a[108:109], v55 offset:24576
    ds_read_b64_tr_b16 a[110:111], v55 offset:26624
    buffer_load_dwordx4 v[128:131], v18, s[16:19], s28 offen offset:0 sc1
    v_mfma_f32_16x16x32_bf16 v[84:87], a[40:43], v[140:143], v[84:87]
    ds_read_b64_tr_b16 a[112:113], v56 offset:24576
    v_mfma_f32_16x16x32_bf16 v[88:91], a[44:47], v[136:139], v[88:91]
    ds_read_b64_tr_b16 a[114:115], v56 offset:26624
    v_mfma_f32_16x16x32_bf16 v[92:95], a[44:47], v[140:143], v[92:95]
    ds_read_b64_tr_b16 a[116:117], v57 offset:24576
    v_mfma_f32_16x16x32_bf16 v[96:99], a[48:51], v[136:139], v[96:99]
    ds_read_b64_tr_b16 a[118:119], v57 offset:26624
    v_mfma_f32_16x16x32_bf16 v[100:103], a[48:51], v[140:143], v[100:103]
    ds_read_b64_tr_b16 a[120:121], v58 offset:24576
    v_mfma_f32_16x16x32_bf16 v[104:107], a[52:55], v[136:139], v[104:107]
    ds_read_b64_tr_b16 a[122:123], v58 offset:26624
    buffer_load_dwordx4 v5, s[12:15], s28 offen offset:3072 lds
    buffer_load_dwordx4 v[132:135], v19, s[16:19], s28 offen offset:0 sc1
    v_mfma_f32_16x16x32_bf16 v[108:111], a[52:55], v[140:143], v[108:111]
    ds_read_b64_tr_b16 a[124:125], v59 offset:24576
    ds_read_b64_tr_b16 a[126:127], v59 offset:26624
    v_mfma_f32_16x16x32_bf16 v[112:115], a[56:59], v[136:139], v[112:115]
    v_mfma_f32_16x16x32_bf16 v[116:119], a[56:59], v[140:143], v[116:119]
    v_mfma_f32_16x16x32_bf16 v[120:123], a[60:63], v[136:139], v[120:123]
    v_mfma_f32_16x16x32_bf16 v[124:127], a[60:63], v[140:143], v[124:127]
    buffer_load_dwordx4 v[136:139], v18, s[16:19], s28 offen offset:2048 sc1
    buffer_load_dwordx4 v[140:143], v19, s[16:19], s28 offen offset:2048 sc1
    s_waitcnt vmcnt(16) lgkmcnt(0)
    s_barrier
    v_mfma_f32_16x16x32_bf16 v[64:67], a[64:67], v[144:147], v[64:67]
    ds_read_b64_tr_b16 a[0:1], v52 offset:32768
    v_mfma_f32_16x16x32_bf16 v[68:71], a[64:67], v[148:151], v[68:71]
    ds_read_b64_tr_b16 a[2:3], v52 offset:34816
    v_mfma_f32_16x16x32_bf16 v[72:75], a[68:71], v[144:147], v[72:75]
    ds_read_b64_tr_b16 a[4:5], v53 offset:32768
    s_bfe_u32 s28, s80, 0x80008
    s_lshl_b32 s28, s28, 17
    s_add_u32 s28, s28, s29
    s_add_u32 m0, s31, 16384
    s_nop 0
    buffer_load_dwordx4 v2, s[12:15], s28 offen offset:0 lds
    v_mfma_f32_16x16x32_bf16 v[76:79], a[68:71], v[148:151], v[76:79]
    ds_read_b64_tr_b16 a[6:7], v53 offset:34816
    v_mfma_f32_16x16x32_bf16 v[80:83], a[72:75], v[144:147], v[80:83]
    ds_read_b64_tr_b16 a[8:9], v54 offset:32768
    v_mfma_f32_16x16x32_bf16 v[84:87], a[72:75], v[148:151], v[84:87]
    ds_read_b64_tr_b16 a[10:11], v54 offset:34816
    v_mfma_f32_16x16x32_bf16 v[88:91], a[76:79], v[144:147], v[88:91]
    ds_read_b64_tr_b16 a[12:13], v55 offset:32768
    ds_read_b64_tr_b16 a[14:15], v55 offset:34816
    v_mfma_f32_16x16x32_bf16 v[92:95], a[76:79], v[148:151], v[92:95]
    ds_read_b64_tr_b16 a[16:17], v56 offset:32768
    v_mfma_f32_16x16x32_bf16 v[96:99], a[80:83], v[144:147], v[96:99]
    ds_read_b64_tr_b16 a[18:19], v56 offset:34816
    v_mfma_f32_16x16x32_bf16 v[100:103], a[80:83], v[148:151], v[100:103]
    ds_read_b64_tr_b16 a[20:21], v57 offset:32768
    v_mfma_f32_16x16x32_bf16 v[104:107], a[84:87], v[144:147], v[104:107]
    ds_read_b64_tr_b16 a[22:23], v57 offset:34816
    buffer_load_dwordx4 v3, s[12:15], s28 offen offset:1024 lds
    v_mfma_f32_16x16x32_bf16 v[108:111], a[84:87], v[148:151], v[108:111]
    ds_read_b64_tr_b16 a[24:25], v58 offset:32768
    v_mfma_f32_16x16x32_bf16 v[112:115], a[88:91], v[144:147], v[112:115]
    ds_read_b64_tr_b16 a[26:27], v58 offset:34816
    v_mfma_f32_16x16x32_bf16 v[116:119], a[88:91], v[148:151], v[116:119]
    ds_read_b64_tr_b16 a[28:29], v59 offset:32768
    ds_read_b64_tr_b16 a[30:31], v59 offset:34816
    v_mfma_f32_16x16x32_bf16 v[120:123], a[92:95], v[144:147], v[120:123]
    ds_read_b64_tr_b16 a[32:33], v52 offset:40960
    v_mfma_f32_16x16x32_bf16 v[124:127], a[92:95], v[148:151], v[124:127]
    ds_read_b64_tr_b16 a[34:35], v52 offset:43008
    v_mfma_f32_16x16x32_bf16 v[64:67], a[96:99], v[152:155], v[64:67]
    ds_read_b64_tr_b16 a[36:37], v53 offset:40960
    v_mfma_f32_16x16x32_bf16 v[68:71], a[96:99], v[156:159], v[68:71]
    ds_read_b64_tr_b16 a[38:39], v53 offset:43008
    v_mfma_f32_16x16x32_bf16 v[72:75], a[100:103], v[152:155], v[72:75]
    ds_read_b64_tr_b16 a[40:41], v54 offset:40960
    buffer_load_dwordx4 v4, s[12:15], s28 offen offset:2048 lds
    v_mfma_f32_16x16x32_bf16 v[76:79], a[100:103], v[156:159], v[76:79]
    ds_read_b64_tr_b16 a[42:43], v54 offset:43008
    v_mfma_f32_16x16x32_bf16 v[80:83], a[104:107], v[152:155], v[80:83]
    ds_read_b64_tr_b16 a[44:45], v55 offset:40960
    ds_read_b64_tr_b16 a[46:47], v55 offset:43008
    buffer_load_dwordx4 v[144:147], v18, s[16:19], s28 offen offset:0 sc1
    v_mfma_f32_16x16x32_bf16 v[84:87], a[104:107], v[156:159], v[84:87]
    ds_read_b64_tr_b16 a[48:49], v56 offset:40960
    v_mfma_f32_16x16x32_bf16 v[88:91], a[108:111], v[152:155], v[88:91]
    ds_read_b64_tr_b16 a[50:51], v56 offset:43008
    v_mfma_f32_16x16x32_bf16 v[92:95], a[108:111], v[156:159], v[92:95]
    ds_read_b64_tr_b16 a[52:53], v57 offset:40960
    v_mfma_f32_16x16x32_bf16 v[96:99], a[112:115], v[152:155], v[96:99]
    ds_read_b64_tr_b16 a[54:55], v57 offset:43008
    v_mfma_f32_16x16x32_bf16 v[100:103], a[112:115], v[156:159], v[100:103]
    ds_read_b64_tr_b16 a[56:57], v58 offset:40960
    v_mfma_f32_16x16x32_bf16 v[104:107], a[116:119], v[152:155], v[104:107]
    ds_read_b64_tr_b16 a[58:59], v58 offset:43008
    buffer_load_dwordx4 v5, s[12:15], s28 offen offset:3072 lds
    buffer_load_dwordx4 v[148:151], v19, s[16:19], s28 offen offset:0 sc1
    v_mfma_f32_16x16x32_bf16 v[108:111], a[116:119], v[156:159], v[108:111]
    ds_read_b64_tr_b16 a[60:61], v59 offset:40960
    ds_read_b64_tr_b16 a[62:63], v59 offset:43008
    v_mfma_f32_16x16x32_bf16 v[112:115], a[120:123], v[152:155], v[112:115]
    v_mfma_f32_16x16x32_bf16 v[116:119], a[120:123], v[156:159], v[116:119]
    v_mfma_f32_16x16x32_bf16 v[120:123], a[124:127], v[152:155], v[120:123]
    v_mfma_f32_16x16x32_bf16 v[124:127], a[124:127], v[156:159], v[124:127]
    buffer_load_dwordx4 v[152:155], v18, s[16:19], s28 offen offset:2048 sc1
    buffer_load_dwordx4 v[156:159], v19, s[16:19], s28 offen offset:2048 sc1
    s_waitcnt vmcnt(20) lgkmcnt(0)
    s_barrier
    v_mfma_f32_16x16x32_bf16 v[64:67], a[0:3], v[160:163], v[64:67]
    ds_read_b64_tr_b16 a[64:65], v52 offset:49152
    v_mfma_f32_16x16x32_bf16 v[68:71], a[0:3], v[164:167], v[68:71]
    ds_read_b64_tr_b16 a[66:67], v52 offset:51200
    v_mfma_f32_16x16x32_bf16 v[72:75], a[4:7], v[160:163], v[72:75]
    ds_read_b64_tr_b16 a[68:69], v53 offset:49152
    s_bfe_u32 s28, s80, 0x80010
    s_lshl_b32 s28, s28, 17
    s_add_u32 s28, s28, s29
    s_add_u32 m0, s31, 32768
    s_nop 0
    buffer_load_dwordx4 v2, s[12:15], s28 offen offset:0 lds
    v_mfma_f32_16x16x32_bf16 v[76:79], a[4:7], v[164:167], v[76:79]
    ds_read_b64_tr_b16 a[70:71], v53 offset:51200
    v_mfma_f32_16x16x32_bf16 v[80:83], a[8:11], v[160:163], v[80:83]
    ds_read_b64_tr_b16 a[72:73], v54 offset:49152
    v_mfma_f32_16x16x32_bf16 v[84:87], a[8:11], v[164:167], v[84:87]
    ds_read_b64_tr_b16 a[74:75], v54 offset:51200
    v_mfma_f32_16x16x32_bf16 v[88:91], a[12:15], v[160:163], v[88:91]
    ds_read_b64_tr_b16 a[76:77], v55 offset:49152
    ds_read_b64_tr_b16 a[78:79], v55 offset:51200
    v_mfma_f32_16x16x32_bf16 v[92:95], a[12:15], v[164:167], v[92:95]
    ds_read_b64_tr_b16 a[80:81], v56 offset:49152
    v_mfma_f32_16x16x32_bf16 v[96:99], a[16:19], v[160:163], v[96:99]
    ds_read_b64_tr_b16 a[82:83], v56 offset:51200
    v_mfma_f32_16x16x32_bf16 v[100:103], a[16:19], v[164:167], v[100:103]
    ds_read_b64_tr_b16 a[84:85], v57 offset:49152
    v_mfma_f32_16x16x32_bf16 v[104:107], a[20:23], v[160:163], v[104:107]
    ds_read_b64_tr_b16 a[86:87], v57 offset:51200
    buffer_load_dwordx4 v3, s[12:15], s28 offen offset:1024 lds
    v_mfma_f32_16x16x32_bf16 v[108:111], a[20:23], v[164:167], v[108:111]
    ds_read_b64_tr_b16 a[88:89], v58 offset:49152
    v_mfma_f32_16x16x32_bf16 v[112:115], a[24:27], v[160:163], v[112:115]
    ds_read_b64_tr_b16 a[90:91], v58 offset:51200
    v_mfma_f32_16x16x32_bf16 v[116:119], a[24:27], v[164:167], v[116:119]
    ds_read_b64_tr_b16 a[92:93], v59 offset:49152
    ds_read_b64_tr_b16 a[94:95], v59 offset:51200
    v_mfma_f32_16x16x32_bf16 v[120:123], a[28:31], v[160:163], v[120:123]
    ds_read_b64_tr_b16 a[96:97], v52 offset:57344
    v_mfma_f32_16x16x32_bf16 v[124:127], a[28:31], v[164:167], v[124:127]
    ds_read_b64_tr_b16 a[98:99], v52 offset:59392
    v_mfma_f32_16x16x32_bf16 v[64:67], a[32:35], v[168:171], v[64:67]
    ds_read_b64_tr_b16 a[100:101], v53 offset:57344
    v_mfma_f32_16x16x32_bf16 v[68:71], a[32:35], v[172:175], v[68:71]
    ds_read_b64_tr_b16 a[102:103], v53 offset:59392
    v_mfma_f32_16x16x32_bf16 v[72:75], a[36:39], v[168:171], v[72:75]
    ds_read_b64_tr_b16 a[104:105], v54 offset:57344
    buffer_load_dwordx4 v4, s[12:15], s28 offen offset:2048 lds
    v_mfma_f32_16x16x32_bf16 v[76:79], a[36:39], v[172:175], v[76:79]
    ds_read_b64_tr_b16 a[106:107], v54 offset:59392
    v_mfma_f32_16x16x32_bf16 v[80:83], a[40:43], v[168:171], v[80:83]
    ds_read_b64_tr_b16 a[108:109], v55 offset:57344
    ds_read_b64_tr_b16 a[110:111], v55 offset:59392
    buffer_load_dwordx4 v[160:163], v18, s[16:19], s28 offen offset:0 sc1
    v_mfma_f32_16x16x32_bf16 v[84:87], a[40:43], v[172:175], v[84:87]
    ds_read_b64_tr_b16 a[112:113], v56 offset:57344
    v_mfma_f32_16x16x32_bf16 v[88:91], a[44:47], v[168:171], v[88:91]
    ds_read_b64_tr_b16 a[114:115], v56 offset:59392
    v_mfma_f32_16x16x32_bf16 v[92:95], a[44:47], v[172:175], v[92:95]
    ds_read_b64_tr_b16 a[116:117], v57 offset:57344
    v_mfma_f32_16x16x32_bf16 v[96:99], a[48:51], v[168:171], v[96:99]
    ds_read_b64_tr_b16 a[118:119], v57 offset:59392
    v_mfma_f32_16x16x32_bf16 v[100:103], a[48:51], v[172:175], v[100:103]
    ds_read_b64_tr_b16 a[120:121], v58 offset:57344
    v_mfma_f32_16x16x32_bf16 v[104:107], a[52:55], v[168:171], v[104:107]
    ds_read_b64_tr_b16 a[122:123], v58 offset:59392
    buffer_load_dwordx4 v5, s[12:15], s28 offen offset:3072 lds
    buffer_load_dwordx4 v[164:167], v19, s[16:19], s28 offen offset:0 sc1
    v_mfma_f32_16x16x32_bf16 v[108:111], a[52:55], v[172:175], v[108:111]
    ds_read_b64_tr_b16 a[124:125], v59 offset:57344
    ds_read_b64_tr_b16 a[126:127], v59 offset:59392
    v_mfma_f32_16x16x32_bf16 v[112:115], a[56:59], v[168:171], v[112:115]
    v_mfma_f32_16x16x32_bf16 v[116:119], a[56:59], v[172:175], v[116:119]
    v_mfma_f32_16x16x32_bf16 v[120:123], a[60:63], v[168:171], v[120:123]
    v_mfma_f32_16x16x32_bf16 v[124:127], a[60:63], v[172:175], v[124:127]
    buffer_load_dwordx4 v[168:171], v18, s[16:19], s28 offen offset:2048 sc1
    buffer_load_dwordx4 v[172:175], v19, s[16:19], s28 offen offset:2048 sc1
    s_waitcnt vmcnt(19) lgkmcnt(0)
    s_barrier
    v_mfma_f32_16x16x32_bf16 v[64:67], a[64:67], v[176:179], v[64:67]
    ds_read_b64_tr_b16 a[0:1], v52 offset:0
    v_mfma_f32_16x16x32_bf16 v[68:71], a[64:67], v[180:183], v[68:71]
    ds_read_b64_tr_b16 a[2:3], v52 offset:2048
    v_mfma_f32_16x16x32_bf16 v[72:75], a[68:71], v[176:179], v[72:75]
    ds_read_b64_tr_b16 a[4:5], v53 offset:0
    s_bfe_u32 s28, s80, 0x80018
    s_lshl_b32 s28, s28, 17
    s_add_u32 s28, s28, s29
    s_add_u32 m0, s31, 49152
    s_nop 0
    buffer_load_dwordx4 v2, s[12:15], s28 offen offset:0 lds
    v_mfma_f32_16x16x32_bf16 v[76:79], a[68:71], v[180:183], v[76:79]
    ds_read_b64_tr_b16 a[6:7], v53 offset:2048
    v_mfma_f32_16x16x32_bf16 v[80:83], a[72:75], v[176:179], v[80:83]
    ds_read_b64_tr_b16 a[8:9], v54 offset:0
    v_mfma_f32_16x16x32_bf16 v[84:87], a[72:75], v[180:183], v[84:87]
    ds_read_b64_tr_b16 a[10:11], v54 offset:2048
    v_mfma_f32_16x16x32_bf16 v[88:91], a[76:79], v[176:179], v[88:91]
    ds_read_b64_tr_b16 a[12:13], v55 offset:0
    ds_read_b64_tr_b16 a[14:15], v55 offset:2048
    v_mfma_f32_16x16x32_bf16 v[92:95], a[76:79], v[180:183], v[92:95]
    ds_read_b64_tr_b16 a[16:17], v56 offset:0
    v_mfma_f32_16x16x32_bf16 v[96:99], a[80:83], v[176:179], v[96:99]
    ds_read_b64_tr_b16 a[18:19], v56 offset:2048
    v_mfma_f32_16x16x32_bf16 v[100:103], a[80:83], v[180:183], v[100:103]
    ds_read_b64_tr_b16 a[20:21], v57 offset:0
    v_mfma_f32_16x16x32_bf16 v[104:107], a[84:87], v[176:179], v[104:107]
    ds_read_b64_tr_b16 a[22:23], v57 offset:2048
    buffer_load_dwordx4 v3, s[12:15], s28 offen offset:1024 lds
    v_mfma_f32_16x16x32_bf16 v[108:111], a[84:87], v[180:183], v[108:111]
    ds_read_b64_tr_b16 a[24:25], v58 offset:0
    v_mfma_f32_16x16x32_bf16 v[112:115], a[88:91], v[176:179], v[112:115]
    ds_read_b64_tr_b16 a[26:27], v58 offset:2048
    v_mfma_f32_16x16x32_bf16 v[116:119], a[88:91], v[180:183], v[116:119]
    ds_read_b64_tr_b16 a[28:29], v59 offset:0
    ds_read_b64_tr_b16 a[30:31], v59 offset:2048
    v_mfma_f32_16x16x32_bf16 v[120:123], a[92:95], v[176:179], v[120:123]
    ds_read_b64_tr_b16 a[32:33], v52 offset:8192
    v_mfma_f32_16x16x32_bf16 v[124:127], a[92:95], v[180:183], v[124:127]
    ds_read_b64_tr_b16 a[34:35], v52 offset:10240
    v_mfma_f32_16x16x32_bf16 v[64:67], a[96:99], v[184:187], v[64:67]
    ds_read_b64_tr_b16 a[36:37], v53 offset:8192
    v_mfma_f32_16x16x32_bf16 v[68:71], a[96:99], v[188:191], v[68:71]
    ds_read_b64_tr_b16 a[38:39], v53 offset:10240
    v_mfma_f32_16x16x32_bf16 v[72:75], a[100:103], v[184:187], v[72:75]
    ds_read_b64_tr_b16 a[40:41], v54 offset:8192
    buffer_load_dwordx4 v4, s[12:15], s28 offen offset:2048 lds
    v_mfma_f32_16x16x32_bf16 v[76:79], a[100:103], v[188:191], v[76:79]
    ds_read_b64_tr_b16 a[42:43], v54 offset:10240
    v_mfma_f32_16x16x32_bf16 v[80:83], a[104:107], v[184:187], v[80:83]
    ds_read_b64_tr_b16 a[44:45], v55 offset:8192
    ds_read_b64_tr_b16 a[46:47], v55 offset:10240
    buffer_load_dwordx4 v[176:179], v18, s[16:19], s28 offen offset:0 sc1
    v_mfma_f32_16x16x32_bf16 v[84:87], a[104:107], v[188:191], v[84:87]
    ds_read_b64_tr_b16 a[48:49], v56 offset:8192
    v_mfma_f32_16x16x32_bf16 v[88:91], a[108:111], v[184:187], v[88:91]
    ds_read_b64_tr_b16 a[50:51], v56 offset:10240
    v_mfma_f32_16x16x32_bf16 v[92:95], a[108:111], v[188:191], v[92:95]
    ds_read_b64_tr_b16 a[52:53], v57 offset:8192
    v_mfma_f32_16x16x32_bf16 v[96:99], a[112:115], v[184:187], v[96:99]
    ds_read_b64_tr_b16 a[54:55], v57 offset:10240
    v_mfma_f32_16x16x32_bf16 v[100:103], a[112:115], v[188:191], v[100:103]
    ds_read_b64_tr_b16 a[56:57], v58 offset:8192
    v_mfma_f32_16x16x32_bf16 v[104:107], a[116:119], v[184:187], v[104:107]
    ds_read_b64_tr_b16 a[58:59], v58 offset:10240
    buffer_load_dwordx4 v5, s[12:15], s28 offen offset:3072 lds
    buffer_load_dwordx4 v[180:183], v19, s[16:19], s28 offen offset:0 sc1
    v_mfma_f32_16x16x32_bf16 v[108:111], a[116:119], v[188:191], v[108:111]
    ds_read_b64_tr_b16 a[60:61], v59 offset:8192
    ds_read_b64_tr_b16 a[62:63], v59 offset:10240
    v_mfma_f32_16x16x32_bf16 v[112:115], a[120:123], v[184:187], v[112:115]
    v_mfma_f32_16x16x32_bf16 v[116:119], a[120:123], v[188:191], v[116:119]
    v_mfma_f32_16x16x32_bf16 v[120:123], a[124:127], v[184:187], v[120:123]
    v_mfma_f32_16x16x32_bf16 v[124:127], a[124:127], v[188:191], v[124:127]
    buffer_load_dwordx4 v[184:187], v18, s[16:19], s28 offen offset:2048 sc1
    buffer_load_dwordx4 v[188:191], v19, s[16:19], s28 offen offset:2048 sc1
    s_mov_b32 s80, s81
    s_mov_b32 s81, s82
    s_mov_b32 s82, s83
    s_mov_b32 s83, s84
    s_mov_b32 s84, s85
    s_mov_b32 s85, s86
    s_mov_b32 s86, s87
    s_mov_b32 s87, s88
    s_mov_b32 s30, 1
L3_loop:
    s_cmp_lt_u32 s30, 7
    s_cselect_b32 s14, s14, 0
    s_cselect_b32 s18, s18, 0
    s_waitcnt vmcnt(19) lgkmcnt(0)
    s_barrier
    v_mfma_f32_16x16x32_bf16 v[64:67], a[0:3], v[128:131], v[64:67]
    ds_read_b64_tr_b16 a[64:65], v52 offset:16384
    v_mfma_f32_16x16x32_bf16 v[68:71], a[0:3], v[132:135], v[68:71]
    ds_read_b64_tr_b16 a[66:67], v52 offset:18432
    v_mfma_f32_16x16x32_bf16 v[72:75], a[4:7], v[128:131], v[72:75]
    ds_read_b64_tr_b16 a[68:69], v53 offset:16384
    s_bfe_u32 s28, s80, 0x80000
    s_lshl_b32 s28, s28, 17
    s_add_u32 s28, s28, s29
    s_add_u32 m0, s31, 0
    s_nop 0
    buffer_load_dwordx4 v2, s[12:15], s28 offen offset:0 lds
    v_mfma_f32_16x16x32_bf16 v[76:79], a[4:7], v[132:135], v[76:79]
    ds_read_b64_tr_b16 a[70:71], v53 offset:18432
    v_mfma_f32_16x16x32_bf16 v[80:83], a[8:11], v[128:131], v[80:83]
    ds_read_b64_tr_b16 a[72:73], v54 offset:16384
    v_mfma_f32_16x16x32_bf16 v[84:87], a[8:11], v[132:135], v[84:87]
    ds_read_b64_tr_b16 a[74:75], v54 offset:18432
    v_mfma_f32_16x16x32_bf16 v[88:91], a[12:15], v[128:131], v[88:91]
    ds_read_b64_tr_b16 a[76:77], v55 offset:16384
    ds_read_b64_tr_b16 a[78:79], v55 offset:18432
    v_mfma_f32_16x16x32_bf16 v[92:95], a[12:15], v[132:135], v[92:95]
    ds_read_b64_tr_b16 a[80:81], v56 offset:16384
    v_mfma_f32_16x16x32_bf16 v[96:99], a[16:19], v[128:131], v[96:99]
    ds_read_b64_tr_b16 a[82:83], v56 offset:18432
    v_mfma_f32_16x16x32_bf16 v[100:103], a[16:19], v[132:135], v[100:103]
    ds_read_b64_tr_b16 a[84:85], v57 offset:16384
    v_mfma_f32_16x16x32_bf16 v[104:107], a[20:23], v[128:131], v[104:107]
    ds_read_b64_tr_b16 a[86:87], v57 offset:18432
    buffer_load_dwordx4 v3, s[12:15], s28 offen offset:1024 lds
    v_mfma_f32_16x16x32_bf16 v[108:111], a[20:23], v[132:135], v[108:111]
    ds_read_b64_tr_b16 a[88:89], v58 offset:16384
    v_mfma_f32_16x16x32_bf16 v[112:115], a[24:27], v[128:131], v[112:115]
    ds_read_b64_tr_b16 a[90:91], v58 offset:18432
    v_mfma_f32_16x16x32_bf16 v[116:119], a[24:27], v[132:135], v[116:119]
    ds_read_b64_tr_b16 a[92:93], v59 offset:16384
    ds_read_b64_tr_b16 a[94:95], v59 offset:18432
    v_mfma_f32_16x16x32_bf16 v[120:123], a[28:31], v[128:131], v[120:123]
    ds_read_b64_tr_b16 a[96:97], v52 offset:24576
    v_mfma_f32_16x16x32_bf16 v[124:127], a[28:31], v[132:135], v[124:127]
    ds_read_b64_tr_b16 a[98:99], v52 offset:26624
    v_mfma_f32_16x16x32_bf16 v[64:67], a[32:35], v[136:139], v[64:67]
    ds_read_b64_tr_b16 a[100:101], v53 offset:24576
    v_mfma_f32_16x16x32_bf16 v[68:71], a[32:35], v[140:143], v[68:71]
    ds_read_b64_tr_b16 a[102:103], v53 offset:26624
    v_mfma_f32_16x16x32_bf16 v[72:75], a[36:39], v[136:139], v[72:75]
    ds_read_b64_tr_b16 a[104:105], v54 offset:24576
    buffer_load_dwordx4 v4, s[12:15], s28 offen offset:2048 lds
    v_mfma_f32_16x16x32_bf16 v[76:79], a[36:39], v[140:143], v[76:79]
    ds_read_b64_tr_b16 a[106:107], v54 offset:26624
    v_mfma_f32_16x16x32_bf16 v[80:83], a[40:43], v[136:139], v[80:83]
    ds_read_b64_tr_b16 a[108:109], v55 offset:24576
    ds_read_b64_tr_b16 a[110:111], v55 offset:26624
    buffer_load_dwordx4 v[128:131], v18, s[16:19], s28 offen offset:0 sc1
    v_mfma_f32_16x16x32_bf16 v[84:87], a[40:43], v[140:143], v[84:87]
    ds_read_b64_tr_b16 a[112:113], v56 offset:24576
    v_mfma_f32_16x16x32_bf16 v[88:91], a[44:47], v[136:139], v[88:91]
    ds_read_b64_tr_b16 a[114:115], v56 offset:26624
    v_mfma_f32_16x16x32_bf16 v[92:95], a[44:47], v[140:143], v[92:95]
    ds_read_b64_tr_b16 a[116:117], v57 offset:24576
    v_mfma_f32_16x16x32_bf16 v[96:99], a[48:51], v[136:139], v[96:99]
    ds_read_b64_tr_b16 a[118:119], v57 offset:26624
    v_mfma_f32_16x16x32_bf16 v[100:103], a[48:51], v[140:143], v[100:103]
    ds_read_b64_tr_b16 a[120:121], v58 offset:24576
    v_mfma_f32_16x16x32_bf16 v[104:107], a[52:55], v[136:139], v[104:107]
    ds_read_b64_tr_b16 a[122:123], v58 offset:26624
    buffer_load_dwordx4 v5, s[12:15], s28 offen offset:3072 lds
    buffer_load_dwordx4 v[132:135], v19, s[16:19], s28 offen offset:0 sc1
    v_mfma_f32_16x16x32_bf16 v[108:111], a[52:55], v[140:143], v[108:111]
    ds_read_b64_tr_b16 a[124:125], v59 offset:24576
    ds_read_b64_tr_b16 a[126:127], v59 offset:26624
    v_mfma_f32_16x16x32_bf16 v[112:115], a[56:59], v[136:139], v[112:115]
    v_mfma_f32_16x16x32_bf16 v[116:119], a[56:59], v[140:143], v[116:119]
    v_mfma_f32_16x16x32_bf16 v[120:123], a[60:63], v[136:139], v[120:123]
    v_mfma_f32_16x16x32_bf16 v[124:127], a[60:63], v[140:143], v[124:127]
    buffer_load_dwordx4 v[136:139], v18, s[16:19], s28 offen offset:2048 sc1
    buffer_load_dwordx4 v[140:143], v19, s[16:19], s28 offen offset:2048 sc1
    s_waitcnt vmcnt(19) lgkmcnt(0)
    s_barrier
    v_mfma_f32_16x16x32_bf16 v[64:67], a[64:67], v[144:147], v[64:67]
    ds_read_b64_tr_b16 a[0:1], v52 offset:32768
    v_mfma_f32_16x16x32_bf16 v[68:71], a[64:67], v[148:151], v[68:71]
    ds_read_b64_tr_b16 a[2:3], v52 offset:34816
    v_mfma_f32_16x16x32_bf16 v[72:75], a[68:71], v[144:147], v[72:75]
    ds_read_b64_tr_b16 a[4:5], v53 offset:32768
    s_bfe_u32 s28, s80, 0x80008
    s_lshl_b32 s28, s28, 17
    s_add_u32 s28, s28, s29
    s_add_u32 m0, s31, 16384
    s_nop 0
    buffer_load_dwordx4 v2, s[12:15], s28 offen offset:0 lds
    v_mfma_f32_16x16x32_bf16 v[76:79], a[68:71], v[148:151], v[76:79]
    ds_read_b64_tr_b16 a[6:7], v53 offset:34816
    v_mfma_f32_16x16x32_bf16 v[80:83], a[72:75], v[144:147], v[80:83]
    ds_read_b64_tr_b16 a[8:9], v54 offset:32768
    v_mfma_f32_16x16x32_bf16 v[84:87], a[72:75], v[148:151], v[84:87]
    ds_read_b64_tr_b16 a[10:11], v54 offset:34816
    v_mfma_f32_16x16x32_bf16 v[88:91], a[76:79], v[144:147], v[88:91]
    ds_read_b64_tr_b16 a[12:13], v55 offset:32768
    ds_read_b64_tr_b16 a[14:15], v55 offset:34816
    v_mfma_f32_16x16x32_bf16 v[92:95], a[76:79], v[148:151], v[92:95]
    ds_read_b64_tr_b16 a[16:17], v56 offset:32768
    v_mfma_f32_16x16x32_bf16 v[96:99], a[80:83], v[144:147], v[96:99]
    ds_read_b64_tr_b16 a[18:19], v56 offset:34816
    v_mfma_f32_16x16x32_bf16 v[100:103], a[80:83], v[148:151], v[100:103]
    ds_read_b64_tr_b16 a[20:21], v57 offset:32768
    v_mfma_f32_16x16x32_bf16 v[104:107], a[84:87], v[144:147], v[104:107]
    ds_read_b64_tr_b16 a[22:23], v57 offset:34816
    buffer_load_dwordx4 v3, s[12:15], s28 offen offset:1024 lds
    v_mfma_f32_16x16x32_bf16 v[108:111], a[84:87], v[148:151], v[108:111]
    ds_read_b64_tr_b16 a[24:25], v58 offset:32768
    v_mfma_f32_16x16x32_bf16 v[112:115], a[88:91], v[144:147], v[112:115]
    ds_read_b64_tr_b16 a[26:27], v58 offset:34816
    v_mfma_f32_16x16x32_bf16 v[116:119], a[88:91], v[148:151], v[116:119]
    ds_read_b64_tr_b16 a[28:29], v59 offset:32768
    ds_read_b64_tr_b16 a[30:31], v59 offset:34816
    v_mfma_f32_16x16x32_bf16 v[120:123], a[92:95], v[144:147], v[120:123]
    ds_read_b64_tr_b16 a[32:33], v52 offset:40960
    v_mfma_f32_16x16x32_bf16 v[124:127], a[92:95], v[148:151], v[124:127]
    ds_read_b64_tr_b16 a[34:35], v52 offset:43008
    v_mfma_f32_16x16x32_bf16 v[64:67], a[96:99], v[152:155], v[64:67]
    ds_read_b64_tr_b16 a[36:37], v53 offset:40960
    v_mfma_f32_16x16x32_bf16 v[68:71], a[96:99], v[156:159], v[68:71]
    ds_read_b64_tr_b16 a[38:39], v53 offset:43008
    v_mfma_f32_16x16x32_bf16 v[72:75], a[100:103], v[152:155], v[72:75]
    ds_read_b64_tr_b16 a[40:41], v54 offset:40960
    buffer_load_dwordx4 v4, s[12:15], s28 offen offset:2048 lds
    v_mfma_f32_16x16x32_bf16 v[76:79], a[100:103], v[156:159], v[76:79]
    ds_read_b64_tr_b16 a[42:43], v54 offset:43008
    v_mfma_f32_16x16x32_bf16 v[80:83], a[104:107], v[152:155], v[80:83]
    ds_read_b64_tr_b16 a[44:45], v55 offset:40960
    ds_read_b64_tr_b16 a[46:47], v55 offset:43008
    buffer_load_dwordx4 v[144:147], v18, s[16:19], s28 offen offset:0 sc1
    v_mfma_f32_16x16x32_bf16 v[84:87], a[104:107], v[156:159], v[84:87]
    ds_read_b64_tr_b16 a[48:49], v56 offset:40960
    v_mfma_f32_16x16x32_bf16 v[88:91], a[108:111], v[152:155], v[88:91]
    ds_read_b64_tr_b16 a[50:51], v56 offset:43008
    v_mfma_f32_16x16x32_bf16 v[92:95], a[108:111], v[156:159], v[92:95]
    ds_read_b64_tr_b16 a[52:53], v57 offset:40960
    v_mfma_f32_16x16x32_bf16 v[96:99], a[112:115], v[152:155], v[96:99]
    ds_read_b64_tr_b16 a[54:55], v57 offset:43008
    v_mfma_f32_16x16x32_bf16 v[100:103], a[112:115], v[156:159], v[100:103]
    ds_read_b64_tr_b16 a[56:57], v58 offset:40960
    v_mfma_f32_16x16x32_bf16 v[104:107], a[116:119], v[152:155], v[104:107]
    ds_read_b64_tr_b16 a[58:59], v58 offset:43008
    buffer_load_dwordx4 v5, s[12:15], s28 offen offset:3072 lds
    buffer_load_dwordx4 v[148:151], v19, s[16:19], s28 offen offset:0 sc1
    v_mfma_f32_16x16x32_bf16 v[108:111], a[116:119], v[156:159], v[108:111]
    ds_read_b64_tr_b16 a[60:61], v59 offset:40960
    ds_read_b64_tr_b16 a[62:63], v59 offset:43008
    v_mfma_f32_16x16x32_bf16 v[112:115], a[120:123], v[152:155], v[112:115]
    v_mfma_f32_16x16x32_bf16 v[116:119], a[120:123], v[156:159], v[116:119]
    v_mfma_f32_16x16x32_bf16 v[120:123], a[124:127], v[152:155], v[120:123]
    v_mfma_f32_16x16x32_bf16 v[124:127], a[124:127], v[156:159], v[124:127]
    buffer_load_dwordx4 v[152:155], v18, s[16:19], s28 offen offset:2048 sc1
    buffer_load_dwordx4 v[156:159], v19, s[16:19], s28 offen offset:2048 sc1
    s_waitcnt vmcnt(19) lgkmcnt(0)
    s_barrier
    v_mfma_f32_16x16x32_bf16 v[64:67], a[0:3], v[160:163], v[64:67]
    ds_read_b64_tr_b16 a[64:65], v52 offset:49152
    v_mfma_f32_16x16x32_bf16 v[68:71], a[0:3], v[164:167], v[68:71]
    ds_read_b64_tr_b16 a[66:67], v52 offset:51200
    v_mfma_f32_16x16x32_bf16 v[72:75], a[4:7], v[160:163], v[72:75]
    ds_read_b64_tr_b16 a[68:69], v53 offset:49152
    s_bfe_u32 s28, s80, 0x80010
    s_lshl_b32 s28, s28, 17
    s_add_u32 s28, s28, s29
    s_add_u32 m0, s31, 32768
    s_nop 0
    buffer_load_dwordx4 v2, s[12:15], s28 offen offset:0 lds
    v_mfma_f32_16x16x32_bf16 v[76:79], a[4:7], v[164:167], v[76:79]
    ds_read_b64_tr_b16 a[70:71], v53 offset:51200
    v_mfma_f32_16x16x32_bf16 v[80:83], a[8:11], v[160:163], v[80:83]
    ds_read_b64_tr_b16 a[72:73], v54 offset:49152
    v_mfma_f32_16x16x32_bf16 v[84:87], a[8:11], v[164:167], v[84:87]
    ds_read_b64_tr_b16 a[74:75], v54 offset:51200
    v_mfma_f32_16x16x32_bf16 v[88:91], a[12:15], v[160:163], v[88:91]
    ds_read_b64_tr_b16 a[76:77], v55 offset:49152
    ds_read_b64_tr_b16 a[78:79], v55 offset:51200
    v_mfma_f32_16x16x32_bf16 v[92:95], a[12:15], v[164:167], v[92:95]
    ds_read_b64_tr_b16 a[80:81], v56 offset:49152
    v_mfma_f32_16x16x32_bf16 v[96:99], a[16:19], v[160:163], v[96:99]
    ds_read_b64_tr_b16 a[82:83], v56 offset:51200
    v_mfma_f32_16x16x32_bf16 v[100:103], a[16:19], v[164:167], v[100:103]
    ds_read_b64_tr_b16 a[84:85], v57 offset:49152
    v_mfma_f32_16x16x32_bf16 v[104:107], a[20:23], v[160:163], v[104:107]
    ds_read_b64_tr_b16 a[86:87], v57 offset:51200
    buffer_load_dwordx4 v3, s[12:15], s28 offen offset:1024 lds
    v_mfma_f32_16x16x32_bf16 v[108:111], a[20:23], v[164:167], v[108:111]
    ds_read_b64_tr_b16 a[88:89], v58 offset:49152
    v_mfma_f32_16x16x32_bf16 v[112:115], a[24:27], v[160:163], v[112:115]
    ds_read_b64_tr_b16 a[90:91], v58 offset:51200
    v_mfma_f32_16x16x32_bf16 v[116:119], a[24:27], v[164:167], v[116:119]
    ds_read_b64_tr_b16 a[92:93], v59 offset:49152
    ds_read_b64_tr_b16 a[94:95], v59 offset:51200
    v_mfma_f32_16x16x32_bf16 v[120:123], a[28:31], v[160:163], v[120:123]
    ds_read_b64_tr_b16 a[96:97], v52 offset:57344
    v_mfma_f32_16x16x32_bf16 v[124:127], a[28:31], v[164:167], v[124:127]
    ds_read_b64_tr_b16 a[98:99], v52 offset:59392
    v_mfma_f32_16x16x32_bf16 v[64:67], a[32:35], v[168:171], v[64:67]
    ds_read_b64_tr_b16 a[100:101], v53 offset:57344
    v_mfma_f32_16x16x32_bf16 v[68:71], a[32:35], v[172:175], v[68:71]
    ds_read_b64_tr_b16 a[102:103], v53 offset:59392
    v_mfma_f32_16x16x32_bf16 v[72:75], a[36:39], v[168:171], v[72:75]
    ds_read_b64_tr_b16 a[104:105], v54 offset:57344
    buffer_load_dwordx4 v4, s[12:15], s28 offen offset:2048 lds
    v_mfma_f32_16x16x32_bf16 v[76:79], a[36:39], v[172:175], v[76:79]
    ds_read_b64_tr_b16 a[106:107], v54 offset:59392
    v_mfma_f32_16x16x32_bf16 v[80:83], a[40:43], v[168:171], v[80:83]
    ds_read_b64_tr_b16 a[108:109], v55 offset:57344
    ds_read_b64_tr_b16 a[110:111], v55 offset:59392
    buffer_load_dwordx4 v[160:163], v18, s[16:19], s28 offen offset:0 sc1
    v_mfma_f32_16x16x32_bf16 v[84:87], a[40:43], v[172:175], v[84:87]
    ds_read_b64_tr_b16 a[112:113], v56 offset:57344
    v_mfma_f32_16x16x32_bf16 v[88:91], a[44:47], v[168:171], v[88:91]
    ds_read_b64_tr_b16 a[114:115], v56 offset:59392
    v_mfma_f32_16x16x32_bf16 v[92:95], a[44:47], v[172:175], v[92:95]
    ds_read_b64_tr_b16 a[116:117], v57 offset:57344
    v_mfma_f32_16x16x32_bf16 v[96:99], a[48:51], v[168:171], v[96:99]
    ds_read_b64_tr_b16 a[118:119], v57 offset:59392
    v_mfma_f32_16x16x32_bf16 v[100:103], a[48:51], v[172:175], v[100:103]
    ds_read_b64_tr_b16 a[120:121], v58 offset:57344
    v_mfma_f32_16x16x32_bf16 v[104:107], a[52:55], v[168:171], v[104:107]
    ds_read_b64_tr_b16 a[122:123], v58 offset:59392
    buffer_load_dwordx4 v5, s[12:15], s28 offen offset:3072 lds
    buffer_load_dwordx4 v[164:167], v19, s[16:19], s28 offen offset:0 sc1
    v_mfma_f32_16x16x32_bf16 v[108:111], a[52:55], v[172:175], v[108:111]
    ds_read_b64_tr_b16 a[124:125], v59 offset:57344
    ds_read_b64_tr_b16 a[126:127], v59 offset:59392
    v_mfma_f32_16x16x32_bf16 v[112:115], a[56:59], v[168:171], v[112:115]
    v_mfma_f32_16x16x32_bf16 v[116:119], a[56:59], v[172:175], v[116:119]
    v_mfma_f32_16x16x32_bf16 v[120:123], a[60:63], v[168:171], v[120:123]
    v_mfma_f32_16x16x32_bf16 v[124:127], a[60:63], v[172:175], v[124:127]
    buffer_load_dwordx4 v[168:171], v18, s[16:19], s28 offen offset:2048 sc1
    buffer_load_dwordx4 v[172:175], v19, s[16:19], s28 offen offset:2048 sc1
    s_waitcnt vmcnt(19) lgkmcnt(0)
    s_barrier
    v_mfma_f32_16x16x32_bf16 v[64:67], a[64:67], v[176:179], v[64:67]
    ds_read_b64_tr_b16 a[0:1], v52 offset:0
    v_mfma_f32_16x16x32_bf16 v[68:71], a[64:67], v[180:183], v[68:71]
    ds_read_b64_tr_b16 a[2:3], v52 offset:2048
    v_mfma_f32_16x16x32_bf16 v[72:75], a[68:71], v[176:179], v[72:75]
    ds_read_b64_tr_b16 a[4:5], v53 offset:0
    s_bfe_u32 s28, s80, 0x80018
    s_lshl_b32 s28, s28, 17
    s_add_u32 s28, s28, s29
    s_add_u32 m0, s31, 49152
    s_nop 0
    buffer_load_dwordx4 v2, s[12:15], s28 offen offset:0 lds
    v_mfma_f32_16x16x32_bf16 v[76:79], a[68:71], v[180:183], v[76:79]
    ds_read_b64_tr_b16 a[6:7], v53 offset:2048
    v_mfma_f32_16x16x32_bf16 v[80:83], a[72:75], v[176:179], v[80:83]
    ds_read_b64_tr_b16 a[8:9], v54 offset:0
    v_mfma_f32_16x16x32_bf16 v[84:87], a[72:75], v[180:183], v[84:87]
    ds_read_b64_tr_b16 a[10:11], v54 offset:2048
    v_mfma_f32_16x16x32_bf16 v[88:91], a[76:79], v[176:179], v[88:91]
    ds_read_b64_tr_b16 a[12:13], v55 offset:0
    ds_read_b64_tr_b16 a[14:15], v55 offset:2048
    v_mfma_f32_16x16x32_bf16 v[92:95], a[76:79], v[180:183], v[92:95]
    ds_read_b64_tr_b16 a[16:17], v56 offset:0
    v_mfma_f32_16x16x32_bf16 v[96:99], a[80:83], v[176:179], v[96:99]
    ds_read_b64_tr_b16 a[18:19], v56 offset:2048
    v_mfma_f32_16x16x32_bf16 v[100:103], a[80:83], v[180:183], v[100:103]
    ds_read_b64_tr_b16 a[20:21], v57 offset:0
    v_mfma_f32_16x16x32_bf16 v[104:107], a[84:87], v[176:179], v[104:107]
    ds_read_b64_tr_b16 a[22:23], v57 offset:2048
    buffer_load_dwordx4 v3, s[12:15], s28 offen offset:1024 lds
    v_mfma_f32_16x16x32_bf16 v[108:111], a[84:87], v[180:183], v[108:111]
    ds_read_b64_tr_b16 a[24:25], v58 offset:0
    v_mfma_f32_16x16x32_bf16 v[112:115], a[88:91], v[176:179], v[112:115]
    ds_read_b64_tr_b16 a[26:27], v58 offset:2048
    v_mfma_f32_16x16x32_bf16 v[116:119], a[88:91], v[180:183], v[116:119]
    ds_read_b64_tr_b16 a[28:29], v59 offset:0
    ds_read_b64_tr_b16 a[30:31], v59 offset:2048
    v_mfma_f32_16x16x32_bf16 v[120:123], a[92:95], v[176:179], v[120:123]
    ds_read_b64_tr_b16 a[32:33], v52 offset:8192
    v_mfma_f32_16x16x32_bf16 v[124:127], a[92:95], v[180:183], v[124:127]
    ds_read_b64_tr_b16 a[34:35], v52 offset:10240
    v_mfma_f32_16x16x32_bf16 v[64:67], a[96:99], v[184:187], v[64:67]
    ds_read_b64_tr_b16 a[36:37], v53 offset:8192
    v_mfma_f32_16x16x32_bf16 v[68:71], a[96:99], v[188:191], v[68:71]
    ds_read_b64_tr_b16 a[38:39], v53 offset:10240
    v_mfma_f32_16x16x32_bf16 v[72:75], a[100:103], v[184:187], v[72:75]
    ds_read_b64_tr_b16 a[40:41], v54 offset:8192
    buffer_load_dwordx4 v4, s[12:15], s28 offen offset:2048 lds
    v_mfma_f32_16x16x32_bf16 v[76:79], a[100:103], v[188:191], v[76:79]
    ds_read_b64_tr_b16 a[42:43], v54 offset:10240
    v_mfma_f32_16x16x32_bf16 v[80:83], a[104:107], v[184:187], v[80:83]
    ds_read_b64_tr_b16 a[44:45], v55 offset:8192
    ds_read_b64_tr_b16 a[46:47], v55 offset:10240
    buffer_load_dwordx4 v[176:179], v18, s[16:19], s28 offen offset:0 sc1
    v_mfma_f32_16x16x32_bf16 v[84:87], a[104:107], v[188:191], v[84:87]
    ds_read_b64_tr_b16 a[48:49], v56 offset:8192
    v_mfma_f32_16x16x32_bf16 v[88:91], a[108:111], v[184:187], v[88:91]
    ds_read_b64_tr_b16 a[50:51], v56 offset:10240
    v_mfma_f32_16x16x32_bf16 v[92:95], a[108:111], v[188:191], v[92:95]
    ds_read_b64_tr_b16 a[52:53], v57 offset:8192
    v_mfma_f32_16x16x32_bf16 v[96:99], a[112:115], v[184:187], v[96:99]
    ds_read_b64_tr_b16 a[54:55], v57 offset:10240
    v_mfma_f32_16x16x32_bf16 v[100:103], a[112:115], v[188:191], v[100:103]
    ds_read_b64_tr_b16 a[56:57], v58 offset:8192
    v_mfma_f32_16x16x32_bf16 v[104:107], a[116:119], v[184:187], v[104:107]
    ds_read_b64_tr_b16 a[58:59], v58 offset:10240
    buffer_load_dwordx4 v5, s[12:15], s28 offen offset:3072 lds
    buffer_load_dwordx4 v[180:183], v19, s[16:19], s28 offen offset:0 sc1
    v_mfma_f32_16x16x32_bf16 v[108:111], a[116:119], v[188:191], v[108:111]
    ds_read_b64_tr_b16 a[60:61], v59 offset:8192
    ds_read_b64_tr_b16 a[62:63], v59 offset:10240
    v_mfma_f32_16x16x32_bf16 v[112:115], a[120:123], v[184:187], v[112:115]
    v_mfma_f32_16x16x32_bf16 v[116:119], a[120:123], v[188:191], v[116:119]
    v_mfma_f32_16x16x32_bf16 v[120:123], a[124:127], v[184:187], v[120:123]
    v_mfma_f32_16x16x32_bf16 v[124:127], a[124:127], v[188:191], v[124:127]
    buffer_load_dwordx4 v[184:187], v18, s[16:19], s28 offen offset:2048 sc1
    buffer_load_dwordx4 v[188:191], v19, s[16:19], s28 offen offset:2048 sc1
    s_mov_b32 s80, s81
    s_mov_b32 s81, s82
    s_mov_b32 s82, s83
    s_mov_b32 s83, s84
    s_mov_b32 s84, s85
    s_mov_b32 s85, s86
    s_mov_b32 s86, s87
    s_mov_b32 s87, s88
    s_add_u32 s30, s30, 1
    s_cmp_lt_u32 s30, 8
    s_cbranch_scc1 L3_loop
    s_lshl_b32 s32, s2, 2
    s_add_u32 s32, s32, s24
    s_lshl_b32 s32, s32, 13
    s_xor_b32 s33, s32, 65536
    s_add_u32 s35, s32, 4096
    buffer_store_dwordx4 v[96:99], v6, s[36:39], s32 offen offset:0 sc1
    buffer_store_dwordx4 v[100:103], v6, s[36:39], s32 offen offset:1024 sc1
    buffer_store_dwordx4 v[104:107], v6, s[36:39], s32 offen offset:2048 sc1
    buffer_store_dwordx4 v[108:111], v6, s[36:39], s32 offen offset:3072 sc1
    buffer_store_dwordx4 v[112:115], v6, s[36:39], s35 offen offset:0 sc1
    buffer_store_dwordx4 v[116:119], v6, s[36:39], s35 offen offset:1024 sc1
    buffer_store_dwordx4 v[120:123], v6, s[36:39], s35 offen offset:2048 sc1
    buffer_store_dwordx4 v[124:127], v6, s[36:39], s35 offen offset:3072 sc1
    s_lshl_b32 s28, s2, 2
    s_add_u32 s28, s28, s24
    s_lshl_b32 s28, s28, 7
    s_add_u32 s28, s28, 131072
    s_xor_b32 s29, s28, 1024
    v_mov_b32 v12, 1
    v_mov_b32 v13, 0
    s_waitcnt vmcnt(0)
    s_mov_b64 s[46:47], exec
    s_mov_b64 exec, 1
    buffer_store_dword v12, v13, s[76:79], s28 offen sc1
    s_mov_b32 s52, 0
L3_poll2:
    buffer_load_dword v14, v13, s[76:79], s29 offen sc1
    s_add_u32 s52, s52, 1
    s_waitcnt vmcnt(0)
    v_readfirstlane_b32 s32, v14
    s_cmp_ge_u32 s52, 0x20000
    s_cbranch_scc1 L3_polled2
    s_nop 1
    s_cmp_eq_u32 s32, 1
    s_cbranch_scc0 L3_poll2
L3_polled2:
    s_mov_b64 exec, s[46:47]
    s_add_u32 s35, s33, 4096
    buffer_load_dwordx4 v[20:23], v6, s[36:39], s33 offen offset:0 sc1
    buffer_load_dwordx4 v[24:27], v6, s[36:39], s33 offen offset:1024 sc1
    buffer_load_dwordx4 v[28:31], v6, s[36:39], s33 offen offset:2048 sc1
    buffer_load_dwordx4 v[32:35], v6, s[36:39], s33 offen offset:3072 sc1
    buffer_load_dwordx4 v[36:39], v6, s[36:39], s35 offen offset:0 sc1
    buffer_load_dwordx4 v[40:43], v6, s[36:39], s35 offen offset:1024 sc1
    buffer_load_dwordx4 v[44:47], v6, s[36:39], s35 offen offset:2048 sc1
    buffer_load_dwordx4 v[48:51], v6, s[36:39], s35 offen offset:3072 sc1
    s_waitcnt vmcnt(7)
    v_add_f32 v64, v64, v20
    v_add_f32 v65, v65, v21
    v_add_f32 v66, v66, v22
    v_add_f32 v67, v67, v23
    s_waitcnt vmcnt(6)
    v_add_f32 v68, v68, v24
    v_add_f32 v69, v69, v25
    v_add_f32 v70, v70, v26
    v_add_f32 v71, v71, v27
    s_waitcnt vmcnt(5)
    v_add_f32 v72, v72, v28
    v_add_f32 v73, v73, v29
    v_add_f32 v74, v74, v30
    v_add_f32 v75, v75, v31
    s_waitcnt vmcnt(4)
    v_add_f32 v76, v76, v32
    v_add_f32 v77, v77, v33
    v_add_f32 v78, v78, v34
    v_add_f32 v79, v79, v35
    s_waitcnt vmcnt(3)
    v_add_f32 v80, v80, v36
    v_add_f32 v81, v81, v37
    v_add_f32 v82, v82, v38
    v_add_f32 v83, v83, v39
    s_waitcnt vmcnt(2)
    v_add_f32 v84, v84, v40
    v_add_f32 v85, v85, v41
    v_add_f32 v86, v86, v42
    v_add_f32 v87, v87, v43
    s_waitcnt vmcnt(1)
    v_add_f32 v88, v88, v44
    v_add_f32 v89, v89, v45
    v_add_f32 v90, v90, v46
    v_add_f32 v91, v91, v47
    s_waitcnt vmcnt(0)
    v_add_f32 v92, v92, v48
    v_add_f32 v93, v93, v49
    v_add_f32 v94, v94, v50
    v_add_f32 v95, v95, v51
    v_cvt_pk_bf16_f32 v64, v64, v65
    v_cvt_pk_bf16_f32 v65, v66, v67
    v_cvt_pk_bf16_f32 v66, v68, v69
    v_cvt_pk_bf16_f32 v67, v70, v71
    v_cvt_pk_bf16_f32 v72, v72, v73
    v_cvt_pk_bf16_f32 v73, v74, v75
    v_cvt_pk_bf16_f32 v74, v76, v77
    v_cvt_pk_bf16_f32 v75, v78, v79
    v_cvt_pk_bf16_f32 v80, v80, v81
    v_cvt_pk_bf16_f32 v81, v82, v83
    v_cvt_pk_bf16_f32 v82, v84, v85
    v_cvt_pk_bf16_f32 v83, v86, v87
    v_cvt_pk_bf16_f32 v88, v88, v89
    v_cvt_pk_bf16_f32 v89, v90, v91
    v_cvt_pk_bf16_f32 v90, v92, v93
    v_cvt_pk_bf16_f32 v91, v94, v95
    v_permlane16_swap_b32 v64, v66
    v_permlane16_swap_b32 v65, v67
    v_permlane16_swap_b32 v72, v74
    v_permlane16_swap_b32 v73, v75
    v_permlane16_swap_b32 v80, v82
    v_permlane16_swap_b32 v81, v83
    v_permlane16_swap_b32 v88, v90
    v_permlane16_swap_b32 v89, v91
    buffer_store_dwordx4 v[64:67], v7, s[72:75], 0 offen offset:0
    buffer_store_dwordx4 v[72:75], v7, s[72:75], 0 offen offset:32
    buffer_store_dwordx4 v[80:83], v7, s[72:75], 0 offen offset:64
    buffer_store_dwordx4 v[88:91], v7, s[72:75], 0 offen offset:96
L1_end:
    s_endpgm
L1_rs00:
    v_max_f32 v50, v58, v50
    v_mul_f32 v58, s57, v50
    v_sub_f32 v59, v52, v58
    v_mov_b32 v52, v58
    v_exp_f32 v56, v59
    s_nop 1
    v_mul_f32 v54, v54, v56
    v_pk_mul_f32 v[128:129], v[128:129], v[56:57] op_sel_hi:[1,0]
    v_pk_mul_f32 v[130:131], v[130:131], v[56:57] op_sel_hi:[1,0]
    v_pk_mul_f32 v[132:133], v[132:133], v[56:57] op_sel_hi:[1,0]
    v_pk_mul_f32 v[134:135], v[134:135], v[56:57] op_sel_hi:[1,0]
    v_pk_mul_f32 v[136:137], v[136:137], v[56:57] op_sel_hi:[1,0]
    v_pk_mul_f32 v[138:139], v[138:139], v[56:57] op_sel_hi:[1,0]
    v_pk_mul_f32 v[140:141], v[140:141], v[56:57] op_sel_hi:[1,0]
    v_pk_mul_f32 v[142:143], v[142:143], v[56:57] op_sel_hi:[1,0]
    v_pk_mul_f32 v[160:161], v[160:161], v[56:57] op_sel_hi:[1,0]
    v_pk_mul_f32 v[162:163], v[162:163], v[56:57] op_sel_hi:[1,0]
    v_pk_mul_f32 v[164:165], v[164:165], v[56:57] op_sel_hi:[1,0]
    v_pk_mul_f32 v[166:167], v[166:167], v[56:57] op_sel_hi:[1,0]
    v_pk_mul_f32 v[168:169], v[168:169], v[56:57] op_sel_hi:[1,0]
    v_pk_mul_f32 v[170:171], v[170:171], v[56:57] op_sel_hi:[1,0]
    v_pk_mul_f32 v[172:173], v[172:173], v[56:57] op_sel_hi:[1,0]
    v_pk_mul_f32 v[174:175], v[174:175], v[56:57] op_sel_hi:[1,0]
    v_pk_mul_f32 v[192:193], v[192:193], v[56:57] op_sel_hi:[1,0]
    v_pk_mul_f32 v[194:195], v[194:195], v[56:57] op_sel_hi:[1,0]
    v_pk_mul_f32 v[196:197], v[196:197], v[56:57] op_sel_hi:[1,0]
    v_pk_mul_f32 v[198:199], v[198:199], v[56:57] op_sel_hi:[1,0]
    v_pk_mul_f32 v[200:201], v[200:201], v[56:57] op_sel_hi:[1,0]
    v_pk_mul_f32 v[202:203], v[202:203], v[56:57] op_sel_hi:[1,0]
    v_pk_mul_f32 v[204:205], v[204:205], v[56:57] op_sel_hi:[1,0]
    v_pk_mul_f32 v[206:207], v[206:207], v[56:57] op_sel_hi:[1,0]
    v_pk_mul_f32 v[224:225], v[224:225], v[56:57] op_sel_hi:[1,0]
    v_pk_mul_f32 v[226:227], v[226:227], v[56:57] op_sel_hi:[1,0]
    v_pk_mul_f32 v[228:229], v[228:229], v[56:57] op_sel_hi:[1,0]
    v_pk_mul_f32 v[230:231], v[230:231], v[56:57] op_sel_hi:[1,0]
    v_pk_mul_f32 v[232:233], v[232:233], v[56:57] op_sel_hi:[1,0]
    v_pk_mul_f32 v[234:235], v[234:235], v[56:57] op_sel_hi:[1,0]
    v_pk_mul_f32 v[236:237], v[236:237], v[56:57] op_sel_hi:[1,0]
    v_pk_mul_f32 v[238:239], v[238:239], v[56:57] op_sel_hi:[1,0]
    s_nop 1
    s_branch L1_rb00
L1_rs01:
    v_max_f32 v51, v60, v51
    v_mul_f32 v60, s57, v51
    v_sub_f32 v61, v53, v60
    v_mov_b32 v53, v60
    v_exp_f32 v57, v61
    s_nop 1
    v_mul_f32 v55, v55, v57
    v_pk_mul_f32 v[144:145], v[144:145], v[56:57] op_sel:[0,1] op_sel_hi:[1,1]
    v_pk_mul_f32 v[146:147], v[146:147], v[56:57] op_sel:[0,1] op_sel_hi:[1,1]
    v_pk_mul_f32 v[148:149], v[148:149], v[56:57] op_sel:[0,1] op_sel_hi:[1,1]
    v_pk_mul_f32 v[150:151], v[150:151], v[56:57] op_sel:[0,1] op_sel_hi:[1,1]
    v_pk_mul_f32 v[152:153], v[152:153], v[56:57] op_sel:[0,1] op_sel_hi:[1,1]
    v_pk_mul_f32 v[154:155], v[154:155], v[56:57] op_sel:[0,1] op_sel_hi:[1,1]
    v_pk_mul_f32 v[156:157], v[156:157], v[56:57] op_sel:[0,1] op_sel_hi:[1,1]
    v_pk_mul_f32 v[158:159], v[158:159], v[56:57] op_sel:[0,1] op_sel_hi:[1,1]
    v_pk_mul_f32 v[176:177], v[176:177], v[56:57] op_sel:[0,1] op_sel_hi:[1,1]
    v_pk_mul_f32 v[178:179], v[178:179], v[56:57] op_sel:[0,1] op_sel_hi:[1,1]
    v_pk_mul_f32 v[180:181], v[180:181], v[56:57] op_sel:[0,1] op_sel_hi:[1,1]
    v_pk_mul_f32 v[182:183], v[182:183], v[56:57] op_sel:[0,1] op_sel_hi:[1,1]
    v_pk_mul_f32 v[184:185], v[184:185], v[56:57] op_sel:[0,1] op_sel_hi:[1,1]
    v_pk_mul_f32 v[186:187], v[186:187], v[56:57] op_sel:[0,1] op_sel_hi:[1,1]
    v_pk_mul_f32 v[188:189], v[188:189], v[56:57] op_sel:[0,1] op_sel_hi:[1,1]
    v_pk_mul_f32 v[190:191], v[190:191], v[56:57] op_sel:[0,1] op_sel_hi:[1,1]
    v_pk_mul_f32 v[208:209], v[208:209], v[56:57] op_sel:[0,1] op_sel_hi:[1,1]
    v_pk_mul_f32 v[210:211], v[210:211], v[56:57] op_sel:[0,1] op_sel_hi:[1,1]
    v_pk_mul_f32 v[212:213], v[212:213], v[56:57] op_sel:[0,1] op_sel_hi:[1,1]
    v_pk_mul_f32 v[214:215], v[214:215], v[56:57] op_sel:[0,1] op_sel_hi:[1,1]
    v_pk_mul_f32 v[216:217], v[216:217], v[56:57] op_sel:[0,1] op_sel_hi:[1,1]
    v_pk_mul_f32 v[218:219], v[218:219], v[56:57] op_sel:[0,1] op_sel_hi:[1,1]
    v_pk_mul_f32 v[220:221], v[220:221], v[56:57] op_sel:[0,1] op_sel_hi:[1,1]
    v_pk_mul_f32 v[222:223], v[222:223], v[56:57] op_sel:[0,1] op_sel_hi:[1,1]
    v_pk_mul_f32 v[240:241], v[240:241], v[56:57] op_sel:[0,1] op_sel_hi:[1,1]
    v_pk_mul_f32 v[242:243], v[242:243], v[56:57] op_sel:[0,1] op_sel_hi:[1,1]
    v_pk_mul_f32 v[244:245], v[244:245], v[56:57] op_sel:[0,1] op_sel_hi:[1,1]
    v_pk_mul_f32 v[246:247], v[246:247], v[56:57] op_sel:[0,1] op_sel_hi:[1,1]
    v_pk_mul_f32 v[248:249], v[248:249], v[56:57] op_sel:[0,1] op_sel_hi:[1,1]
    v_pk_mul_f32 v[250:251], v[250:251], v[56:57] op_sel:[0,1] op_sel_hi:[1,1]
    v_pk_mul_f32 v[252:253], v[252:253], v[56:57] op_sel:[0,1] op_sel_hi:[1,1]
    v_pk_mul_f32 v[254:255], v[254:255], v[56:57] op_sel:[0,1] op_sel_hi:[1,1]
    s_nop 1
    s_branch L1_rb01
L1_rs10:
    v_max_f32 v50, v58, v50
    v_mul_f32 v58, s57, v50
    v_sub_f32 v59, v52, v58
    v_mov_b32 v52, v58
    v_exp_f32 v56, v59
    s_nop 1
    v_mul_f32 v54, v54, v56
    v_pk_mul_f32 v[128:129], v[128:129], v[56:57] op_sel_hi:[1,0]
    v_pk_mul_f32 v[130:131], v[130:131], v[56:57] op_sel_hi:[1,0]
    v_pk_mul_f32 v[132:133], v[132:133], v[56:57] op_sel_hi:[1,0]
    v_pk_mul_f32 v[134:135], v[134:135], v[56:57] op_sel_hi:[1,0]
    v_pk_mul_f32 v[136:137], v[136:137], v[56:57] op_sel_hi:[1,0]
    v_pk_mul_f32 v[138:139], v[138:139], v[56:57] op_sel_hi:[1,0]
    v_pk_mul_f32 v[140:141], v[140:141], v[56:57] op_sel_hi:[1,0]
    v_pk_mul_f32 v[142:143], v[142:143], v[56:57] op_sel_hi:[1,0]
    v_pk_mul_f32 v[160:161], v[160:161], v[56:57] op_sel_hi:[1,0]
    v_pk_mul_f32 v[162:163], v[162:163], v[56:57] op_sel_hi:[1,0]
    v_pk_mul_f32 v[164:165], v[164:165], v[56:57] op_sel_hi:[1,0]
    v_pk_mul_f32 v[166:167], v[166:167], v[56:57] op_sel_hi:[1,0]
    v_pk_mul_f32 v[168:169], v[168:169], v[56:57] op_sel_hi:[1,0]
    v_pk_mul_f32 v[170:171], v[170:171], v[56:57] op_sel_hi:[1,0]
    v_pk_mul_f32 v[172:173], v[172:173], v[56:57] op_sel_hi:[1,0]
    v_pk_mul_f32 v[174:175], v[174:175], v[56:57] op_sel_hi:[1,0]
    v_pk_mul_f32 v[192:193], v[192:193], v[56:57] op_sel_hi:[1,0]
    v_pk_mul_f32 v[194:195], v[194:195], v[56:57] op_sel_hi:[1,0]
    v_pk_mul_f32 v[196:197], v[196:197], v[56:57] op_sel_hi:[1,0]
    v_pk_mul_f32 v[198:199], v[198:199], v[56:57] op_sel_hi:[1,0]
    v_pk_mul_f32 v[200:201], v[200:201], v[56:57] op_sel_hi:[1,0]
    v_pk_mul_f32 v[202:203], v[202:203], v[56:57] op_sel_hi:[1,0]
    v_pk_mul_f32 v[204:205], v[204:205], v[56:57] op_sel_hi:[1,0]
    v_pk_mul_f32 v[206:207], v[206:207], v[56:57] op_sel_hi:[1,0]
    v_pk_mul_f32 v[224:225], v[224:225], v[56:57] op_sel_hi:[1,0]
    v_pk_mul_f32 v[226:227], v[226:227], v[56:57] op_sel_hi:[1,0]
    v_pk_mul_f32 v[228:229], v[228:229], v[56:57] op_sel_hi:[1,0]
    v_pk_mul_f32 v[230:231], v[230:231], v[56:57] op_sel_hi:[1,0]
    v_pk_mul_f32 v[232:233], v[232:233], v[56:57] op_sel_hi:[1,0]
    v_pk_mul_f32 v[234:235], v[234:235], v[56:57] op_sel_hi:[1,0]
    v_pk_mul_f32 v[236:237], v[236:237], v[56:57] op_sel_hi:[1,0]
    v_pk_mul_f32 v[238:239], v[238:239], v[56:57] op_sel_hi:[1,0]
    s_nop 1
    s_branch L1_rb10
L1_rs11:
    v_max_f32 v51, v60, v51
    v_mul_f32 v60, s57, v51
    v_sub_f32 v61, v53, v60
    v_mov_b32 v53, v60
    v_exp_f32 v57, v61
    s_nop 1
    v_mul_f32 v55, v55, v57
    v_pk_mul_f32 v[144:145], v[144:145], v[56:57] op_sel:[0,1] op_sel_hi:[1,1]
    v_pk_mul_f32 v[146:147], v[146:147], v[56:57] op_sel:[0,1] op_sel_hi:[1,1]
    v_pk_mul_f32 v[148:149], v[148:149], v[56:57] op_sel:[0,1] op_sel_hi:[1,1]
    v_pk_mul_f32 v[150:151], v[150:151], v[56:57] op_sel:[0,1] op_sel_hi:[1,1]
    v_pk_mul_f32 v[152:153], v[152:153], v[56:57] op_sel:[0,1] op_sel_hi:[1,1]
    v_pk_mul_f32 v[154:155], v[154:155], v[56:57] op_sel:[0,1] op_sel_hi:[1,1]
    v_pk_mul_f32 v[156:157], v[156:157], v[56:57] op_sel:[0,1] op_sel_hi:[1,1]
    v_pk_mul_f32 v[158:159], v[158:159], v[56:57] op_sel:[0,1] op_sel_hi:[1,1]
    v_pk_mul_f32 v[176:177], v[176:177], v[56:57] op_sel:[0,1] op_sel_hi:[1,1]
    v_pk_mul_f32 v[178:179], v[178:179], v[56:57] op_sel:[0,1] op_sel_hi:[1,1]
    v_pk_mul_f32 v[180:181], v[180:181], v[56:57] op_sel:[0,1] op_sel_hi:[1,1]
    v_pk_mul_f32 v[182:183], v[182:183], v[56:57] op_sel:[0,1] op_sel_hi:[1,1]
    v_pk_mul_f32 v[184:185], v[184:185], v[56:57] op_sel:[0,1] op_sel_hi:[1,1]
    v_pk_mul_f32 v[186:187], v[186:187], v[56:57] op_sel:[0,1] op_sel_hi:[1,1]
    v_pk_mul_f32 v[188:189], v[188:189], v[56:57] op_sel:[0,1] op_sel_hi:[1,1]
    v_pk_mul_f32 v[190:191], v[190:191], v[56:57] op_sel:[0,1] op_sel_hi:[1,1]
    v_pk_mul_f32 v[208:209], v[208:209], v[56:57] op_sel:[0,1] op_sel_hi:[1,1]
    v_pk_mul_f32 v[210:211], v[210:211], v[56:57] op_sel:[0,1] op_sel_hi:[1,1]
    v_pk_mul_f32 v[212:213], v[212:213], v[56:57] op_sel:[0,1] op_sel_hi:[1,1]
    v_pk_mul_f32 v[214:215], v[214:215], v[56:57] op_sel:[0,1] op_sel_hi:[1,1]
    v_pk_mul_f32 v[216:217], v[216:217], v[56:57] op_sel:[0,1] op_sel_hi:[1,1]
    v_pk_mul_f32 v[218:219], v[218:219], v[56:57] op_sel:[0,1] op_sel_hi:[1,1]
    v_pk_mul_f32 v[220:221], v[220:221], v[56:57] op_sel:[0,1] op_sel_hi:[1,1]
    v_pk_mul_f32 v[222:223], v[222:223], v[56:57] op_sel:[0,1] op_sel_hi:[1,1]
    v_pk_mul_f32 v[240:241], v[240:241], v[56:57] op_sel:[0,1] op_sel_hi:[1,1]
    v_pk_mul_f32 v[242:243], v[242:243], v[56:57] op_sel:[0,1] op_sel_hi:[1,1]
    v_pk_mul_f32 v[244:245], v[244:245], v[56:57] op_sel:[0,1] op_sel_hi:[1,1]
    v_pk_mul_f32 v[246:247], v[246:247], v[56:57] op_sel:[0,1] op_sel_hi:[1,1]
    v_pk_mul_f32 v[248:249], v[248:249], v[56:57] op_sel:[0,1] op_sel_hi:[1,1]
    v_pk_mul_f32 v[250:251], v[250:251], v[56:57] op_sel:[0,1] op_sel_hi:[1,1]
    v_pk_mul_f32 v[252:253], v[252:253], v[56:57] op_sel:[0,1] op_sel_hi:[1,1]
    v_pk_mul_f32 v[254:255], v[254:255], v[56:57] op_sel:[0,1] op_sel_hi:[1,1]
    s_nop 1
    s_branch L1_rb11
.section .rodata,"a"
.p2align 6
.amdhsa_kernel concat_heads__mha_block_cached__mha_block_cached__near_ridge_kernel
  .amdhsa_next_free_vgpr 384
  .amdhsa_next_free_sgpr 102
  .amdhsa_accum_offset 256
  .amdhsa_group_segment_fixed_size 0
  .amdhsa_kernarg_size 104
  .amdhsa_user_sgpr_count 2
  .amdhsa_user_sgpr_kernarg_segment_ptr 1
  .amdhsa_system_sgpr_workgroup_id_x 1
.end_amdhsa_kernel
```
